```python
import torch

def _softmax(x, axis=-1):
    return torch.softmax(x, dim=axis)
def _gelu(x):
    return torch.nn.functional.gelu(x, approximate="tanh")
def _silu(x):
    return torch.nn.functional.silu(x)
def _sigmoid(x):
    return torch.sigmoid(x)
def _layernorm(x, axis=-1, eps=1e-5):
    m = x.mean(dim=axis, keepdim=True)
    v = x.var(dim=axis, keepdim=True, unbiased=False)
    return (x - m) / torch.sqrt(v + eps)
def _scatter_add(tgt, idx, src, axis=0):
    return tgt.clone().index_add_(axis, idx, src)
def _segment_sum(src, seg, n):
    out = torch.zeros((n,) + src.shape[1:], dtype=src.dtype)
    return out.index_add_(0, seg, src)
def _pad(x, pw):
    flat = tuple(v for pair in reversed(pw) for v in pair)
    return torch.nn.functional.pad(x, flat)

kernel_name = 'concat_heads__mha_block__linear_attn_block__prompt'

def setup_inputs():

    _w = (lambda a: (lambda t: t.to(torch.bfloat16) if t.is_floating_point() else t)(torch.as_tensor(a)))
    def _A_setup():
        B, S, D, H = 1, 2048, 1024, 32
        return {
            "x": _w((lambda *s: torch.randn(*s, dtype=torch.bfloat16) * 0.2)(B, S, D)),
            "wqkv": _w((lambda *s: torch.randn(*s, dtype=torch.bfloat16) * 0.2)(D, 3 * D)),
            "wo": _w((lambda *s: torch.randn(*s, dtype=torch.bfloat16) * 0.05)(D, D)),
        }
    _A_in = _A_setup()

    def _B_setup():
        B, S, D = 1, 2048, 1024
        return {
            "x": _w((lambda *s: torch.randn(*s, dtype=torch.bfloat16) * 0.05)(B, S, D)),
            "wqkv": _w((lambda *s: torch.randn(*s, dtype=torch.bfloat16) * 1.6)(D, 3 * D)),
            "wo": _w((lambda *s: torch.randn(*s, dtype=torch.bfloat16) * 0.1)(D, D)),
        }
    _B_in = _B_setup()

    return {
        "A_x": _A_in["x"],
        "A_wqkv": _A_in["wqkv"],
        "A_wo": _A_in["wo"],
        "B_x": _B_in["x"],
        "B_wqkv": _B_in["wqkv"],
        "B_wo": _B_in["wo"],
    }

def reference(A_x, A_wqkv, A_wo, B_x, B_wqkv, B_wo):
    def _A_ref(x, wqkv, wo):
        B, S, D = x.shape
        H = 32
        Dh = D // H
        qkv = (lambda x, *d: x.permute(*d))((x @ wqkv).reshape(B, S, 3, H, Dh), 2, 0, 3, 1, 4)
        q, k, v = qkv[0], qkv[1], qkv[2]
        scores = torch.einsum("bhqd,bhkd->bhqk", q, k) * (Dh ** -0.5)
        p = _softmax(scores, axis=-1)
        o = torch.einsum("bhqk,bhkd->bhqd", p, v)
        return (lambda x, *d: x.permute(*d))(o, 0, 2, 1, 3).reshape(B, S, D) @ wo

    def _B_ref(x, wqkv, wo):
        B, S, D = x.shape
        H = 32; Dh = D // H
        qkv = (lambda x, *d: x.permute(*d))((x @ wqkv).reshape(B, S, 3, H, Dh), 2, 0, 3, 1, 4)
        q, k, v = qkv[0], qkv[1], qkv[2]
        phi = lambda t: torch.where(t > 0, t + 1, torch.exp(t)) + 1e-6
        pq, pk = phi(q), phi(k)
        kv = torch.einsum("bhsd,bhse->bhde", pk, v)
        z = torch.einsum("bhsd->bhd", pk)
        num = torch.einsum("bhqd,bhde->bhqe", pq, kv)
        den = torch.einsum("bhqd,bhd->bhq", pq, z)[..., None] + 1e-6
        o = num / den
        return (lambda x, *d: x.permute(*d))(o, 0, 2, 1, 3).reshape(B, S, D) @ wo

    a = _A_ref(A_x, A_wqkv, A_wo)
    b = _B_ref(B_x, B_wqkv, B_wo)
    return torch.concatenate([a, b], axis=-1)
```

```asm
; @launch kernel=qkv_kernel grid=(256,1,1) block=(512,1,1) lds=159744
; @launch kernel=attn_kernel grid=(256,1,1) block=(512,1,1) lds=151552
.amdgcn_target "amdgcn-amd-amdhsa--gfx950"
.text
.globl qkv_kernel
.p2align 8
.type qkv_kernel,@function
qkv_kernel:
    s_cmp_ge_u32 s2, 256
    s_cbranch_scc1 k1_end

    s_load_dwordx4 s[80:83], s[0:1], 0
    s_load_dwordx4 s[84:87], s[0:1], 24
    s_load_dwordx2 s[12:13], s[0:1], 64
    v_lshrrev_b32 v2, 6, v0
    v_and_b32 v1, 63, v0
    s_bfe_u32 s26, s2, 65539
    s_and_b32 s33, s2, 1
    s_lshl_b32 s33, s33, 2
    s_bfe_u32 s34, s2, 131078
    s_add_u32 s27, s33, s34
    s_and_b32 s33, s2, 6
    s_lshl_b32 s33, s33, 1
    s_bfe_u32 s34, s2, 131076
    s_add_u32 s28, s33, s34
    v_readfirstlane_b32 s29, v2
    s_and_b32 s30, s29, 3
    s_lshr_b32 s31, s29, 2
    s_mov_b32 s7, 0x00020000
    s_cmp_lg_u32 s29, 7
    s_cbranch_scc1 k1_ld_setup
    s_getpc_b64 s[44:45]
    k1_pc:
    s_sub_u32 s44, s44, k1_pc-qkv_kernel
    s_subb_u32 s45, s45, 0
    v_lshlrev_b32 v14, 7, v1
    global_load_dword v15, v14, s[44:45]
    v_add_u32 v2, 8192, v14
    v_min_u32 v2, text_end-qkv_kernel-4, v2
    global_load_dword v15, v2, s[44:45]
    s_branch k1_pf_setup
    k1_ld_setup:
    s_lshl_b32 s33, s27, 19
    s_lshl_b32 s34, s29, 17
    s_add_u32 s33, s33, s34
    s_lshl_b32 s34, s28, 7
    s_lshl_b32 s35, s30, 11
    s_add_u32 s34, s34, s35
    s_lshl_b32 s35, s29, 13
    s_lshl_b32 s36, s30, 12
    s_add_u32 s36, s36, 98304
    s_cmp_lt_u32 s29, 4
    s_cselect_b32 s62, s33, s34
    s_cselect_b32 s23, s35, s36
    s_cselect_b32 s33, 1, 3
    s_cselect_b32 s43, 4, 3
    s_cselect_b32 s39, 1, 3072
    s_cselect_b32 s25, 2, 3
    s_cselect_b32 s34, 3, 1
    s_cselect_b32 s35, 0, 2
    s_cselect_b32 s36, 64, 32
    s_lshl_b32 s40, s33, 14
    s_sub_u32 s40, s40, 1024
    s_lshl_b32 s41, s33, 16
    s_lshl_b32 s42, s33, 12
    s_lshl_b32 s43, s43, 13
    s_lshl_b32 s39, s39, 7
    s_lshl_b32 s25, s25, 21
    s_lshl_b32 s33, s33, 11
    v_lshrrev_b32 v2, 3, v1
    v_mul_u32_u24 v4, s33, v2
    v_lshrrev_b32 v2, 4, v1
    v_and_b32 v2, s34, v2
    v_lshlrev_b32 v2, s35, v2
    v_and_b32 v3, 7, v1
    v_xor_b32 v2, v2, v3
    v_lshlrev_b32 v2, 4, v2
    v_add_u32 v4, v4, v2
    v_xor_b32 v6, s36, v4
    s_add_u32 s63, s62, s40
    s_add_u32 s64, s63, s40
    s_add_u32 s65, s64, s40
    s_add_u32 s66, s62, s41
    s_add_u32 s67, s63, s41
    s_add_u32 s68, s64, s41
    s_add_u32 s69, s65, s41
    s_mov_b32 s6, s25
    s_mov_b32 m0, s23

    s_waitcnt lgkmcnt(0)

    s_cmp_eq_u32 s26, 0
    s_cselect_b32 s80, s80, s84
    s_cselect_b32 s81, s81, s85
    s_cselect_b32 s82, s82, s86
    s_cselect_b32 s83, s83, s87
    s_cmp_lt_u32 s29, 4
    s_cselect_b32 s4, s80, s82
    s_cselect_b32 s5, s81, s83

    buffer_load_dwordx4 v4, s[4:7], s62 offen offset:0 lds
    buffer_load_dwordx4 v6, s[4:7], s63 offen offset:1024 lds
    buffer_load_dwordx4 v4, s[4:7], s64 offen offset:2048 lds
    buffer_load_dwordx4 v6, s[4:7], s65 offen offset:3072 lds
    s_add_u32 m0, m0, s42
    s_nop 0
    buffer_load_dwordx4 v4, s[4:7], s66 offen offset:0 lds
    buffer_load_dwordx4 v6, s[4:7], s67 offen offset:1024 lds
    buffer_load_dwordx4 v4, s[4:7], s68 offen offset:2048 lds
    buffer_load_dwordx4 v6, s[4:7], s69 offen offset:3072 lds
    v_add_u32 v4, s39, v4
    v_add_u32 v6, s39, v6
    s_add_u32 s48, s23, s43
    s_mov_b32 m0, s48
    s_lshl_b32 s32, s28, 1
    s_add_u32 s32, s32, s31
    s_mov_b32 s14, 268435456
    s_mov_b32 s15, 0x00020000
    v_lshlrev_b32 v11, 4, v1

    v_and_b32 v2, 15, v1
    s_lshl_b32 s33, s30, 13
    v_lshlrev_b32 v2, 7, v2
    v_add_u32 v2, s33, v2
    v_lshrrev_b32 v3, 4, v1
    v_bfe_u32 v5, v1, 1, 3
    v_xor_b32 v3, v3, v5
    v_lshlrev_b32 v3, 4, v3
    v_add_u32 v5, v2, v3

    v_lshrrev_b32 v2, 4, v1
    v_lshlrev_b32 v7, 10, v2
    v_bfe_u32 v2, v1, 2, 2
    v_lshlrev_b32 v2, 7, v2
    v_add_u32 v7, v7, v2
    v_bfe_u32 v2, v1, 3, 1
    v_xor_b32 v2, s31, v2
    v_lshlrev_b32 v2, 6, v2
    v_add_u32 v7, v7, v2
    v_bfe_u32 v2, v1, 4, 1
    v_lshlrev_b32 v2, 5, v2
    v_add_u32 v7, v7, v2
    v_and_b32 v2, 3, v1
    v_lshlrev_b32 v2, 3, v2
    v_add_u32 v7, v7, v2
    v_add_u32 v7, 98304, v7

    v_mov_b32 v96, 0
    v_mov_b32 v97, 0
    v_mov_b32 v98, 0
    v_mov_b32 v99, 0
    v_mov_b32 v100, 0
    v_mov_b32 v101, 0
    v_mov_b32 v102, 0
    v_mov_b32 v103, 0
    v_mov_b32 v104, 0
    v_mov_b32 v105, 0
    v_mov_b32 v106, 0
    v_mov_b32 v107, 0
    v_mov_b32 v108, 0
    v_mov_b32 v109, 0
    v_mov_b32 v110, 0
    v_mov_b32 v111, 0
    v_mov_b32 v112, 0
    v_mov_b32 v113, 0
    v_mov_b32 v114, 0
    v_mov_b32 v115, 0
    v_mov_b32 v116, 0
    v_mov_b32 v117, 0
    v_mov_b32 v118, 0
    v_mov_b32 v119, 0
    v_mov_b32 v120, 0
    v_mov_b32 v121, 0
    v_mov_b32 v122, 0
    v_mov_b32 v123, 0
    v_mov_b32 v124, 0
    v_mov_b32 v125, 0
    v_mov_b32 v126, 0
    v_mov_b32 v127, 0
    v_mov_b32 v128, 0
    v_mov_b32 v129, 0
    v_mov_b32 v130, 0
    v_mov_b32 v131, 0
    v_mov_b32 v132, 0
    v_mov_b32 v133, 0
    v_mov_b32 v134, 0
    v_mov_b32 v135, 0
    v_mov_b32 v136, 0
    v_mov_b32 v137, 0
    v_mov_b32 v138, 0
    v_mov_b32 v139, 0
    v_mov_b32 v140, 0
    v_mov_b32 v141, 0
    v_mov_b32 v142, 0
    v_mov_b32 v143, 0
    v_mov_b32 v144, 0
    v_mov_b32 v145, 0
    v_mov_b32 v146, 0
    v_mov_b32 v147, 0
    v_mov_b32 v148, 0
    v_mov_b32 v149, 0
    v_mov_b32 v150, 0
    v_mov_b32 v151, 0
    v_mov_b32 v152, 0
    v_mov_b32 v153, 0
    v_mov_b32 v154, 0
    v_mov_b32 v155, 0
    v_mov_b32 v156, 0
    v_mov_b32 v157, 0
    v_mov_b32 v158, 0
    v_mov_b32 v159, 0
    v_mov_b32 v160, 0
    v_mov_b32 v161, 0
    v_mov_b32 v162, 0
    v_mov_b32 v163, 0
    v_mov_b32 v164, 0
    v_mov_b32 v165, 0
    v_mov_b32 v166, 0
    v_mov_b32 v167, 0
    v_mov_b32 v168, 0
    v_mov_b32 v169, 0
    v_mov_b32 v170, 0
    v_mov_b32 v171, 0
    v_mov_b32 v172, 0
    v_mov_b32 v173, 0
    v_mov_b32 v174, 0
    v_mov_b32 v175, 0
    v_mov_b32 v176, 0
    v_mov_b32 v177, 0
    v_mov_b32 v178, 0
    v_mov_b32 v179, 0
    v_mov_b32 v180, 0
    v_mov_b32 v181, 0
    v_mov_b32 v182, 0
    v_mov_b32 v183, 0
    v_mov_b32 v184, 0
    v_mov_b32 v185, 0
    v_mov_b32 v186, 0
    v_mov_b32 v187, 0
    v_mov_b32 v188, 0
    v_mov_b32 v189, 0
    v_mov_b32 v190, 0
    v_mov_b32 v191, 0
    s_add_u32 s18, s23, 4096
    s_mov_b32 s21, 0
    s_mov_b32 s24, 0
    s_mov_b32 s16, 0
    s_mov_b32 s17, 65536
    s_mov_b32 s22, 49152
    v_mov_b32 v8, v5
    v_mov_b32 v10, v7
    v_xor_b32 v9, 32, v7

    s_barrier
    buffer_load_dwordx4 v4, s[4:7], s62 offen offset:0 lds
    buffer_load_dwordx4 v6, s[4:7], s63 offen offset:1024 lds
    buffer_load_dwordx4 v4, s[4:7], s64 offen offset:2048 lds
    buffer_load_dwordx4 v6, s[4:7], s65 offen offset:3072 lds
    s_add_u32 m0, m0, s42
    s_barrier
    buffer_load_dwordx4 v4, s[4:7], s66 offen offset:0 lds
    buffer_load_dwordx4 v6, s[4:7], s67 offen offset:1024 lds
    buffer_load_dwordx4 v4, s[4:7], s68 offen offset:2048 lds
    buffer_load_dwordx4 v6, s[4:7], s69 offen offset:3072 lds
    v_add_u32 v4, s39, v4
    v_add_u32 v6, s39, v6
    s_mov_b32 s47, 0
    s_branch k1_common
k1_pf_setup:
    v_and_b32 v2, 31, v1
    v_lshlrev_b32 v12, 11, v2
    v_min_u32 v2, 47, v1
    v_lshlrev_b32 v13, 11, v2
    s_lshl_b32 s34, s27, 3
    s_and_b32 s35, s28, 7
    s_add_u32 s34, s34, s35
    s_lshr_b32 s33, s28, 3
    s_lshl_b32 s33, s33, 10
    s_lshl_b32 s37, s34, 16
    s_add_u32 s37, s37, s33
    s_mul_i32 s38, s34, 98304
    s_add_u32 s38, s38, s33
    s_mov_b32 s6, 4194304
    s_mov_b32 s10, 6291456
    s_mov_b32 s11, 0x00020000
    s_mov_b32 s42, 4194304
    s_mov_b32 s43, 0x00020000
    s_mov_b32 s66, 6291456
    s_mov_b32 s67, 0x00020000
    s_mov_b32 s47, 1
    s_waitcnt lgkmcnt(0)
    s_mov_b32 s4, s84
    s_mov_b32 s5, s85
    s_mov_b32 s8, s86
    s_mov_b32 s9, s87
    s_mov_b32 s40, s80
    s_mov_b32 s41, s81
    s_mov_b32 s64, s82
    s_mov_b32 s65, s83
    s_sub_u32 s33, 384, s40
    s_and_b32 s33, s33, 896
    s_add_u32 s62, s37, s33
    s_sub_u32 s33, 384, s64
    s_and_b32 s33, s33, 896
    s_add_u32 s63, s38, s33
    s_sub_u32 s33, 384, s4
    s_and_b32 s33, s33, 896
    s_add_u32 s37, s37, s33
    s_sub_u32 s33, 384, s8
    s_and_b32 s33, s33, 896
    s_add_u32 s38, s38, s33

    s_mov_b32 s23, 0
    s_lshl_b32 s32, s28, 1
    s_add_u32 s32, s32, s31
    s_mov_b32 s14, 268435456
    s_mov_b32 s15, 0x00020000
    v_lshlrev_b32 v11, 4, v1

    v_and_b32 v2, 15, v1
    s_lshl_b32 s33, s30, 13
    v_lshlrev_b32 v2, 7, v2
    v_add_u32 v2, s33, v2
    v_lshrrev_b32 v3, 4, v1
    v_bfe_u32 v5, v1, 1, 3
    v_xor_b32 v3, v3, v5
    v_lshlrev_b32 v3, 4, v3
    v_add_u32 v5, v2, v3

    v_lshrrev_b32 v2, 4, v1
    v_lshlrev_b32 v7, 10, v2
    v_bfe_u32 v2, v1, 2, 2
    v_lshlrev_b32 v2, 7, v2
    v_add_u32 v7, v7, v2
    v_bfe_u32 v2, v1, 3, 1
    v_xor_b32 v2, s31, v2
    v_lshlrev_b32 v2, 6, v2
    v_add_u32 v7, v7, v2
    v_bfe_u32 v2, v1, 4, 1
    v_lshlrev_b32 v2, 5, v2
    v_add_u32 v7, v7, v2
    v_and_b32 v2, 3, v1
    v_lshlrev_b32 v2, 3, v2
    v_add_u32 v7, v7, v2
    v_add_u32 v7, 98304, v7

    v_mov_b32 v96, 0
    v_mov_b32 v97, 0
    v_mov_b32 v98, 0
    v_mov_b32 v99, 0
    v_mov_b32 v100, 0
    v_mov_b32 v101, 0
    v_mov_b32 v102, 0
    v_mov_b32 v103, 0
    v_mov_b32 v104, 0
    v_mov_b32 v105, 0
    v_mov_b32 v106, 0
    v_mov_b32 v107, 0
    v_mov_b32 v108, 0
    v_mov_b32 v109, 0
    v_mov_b32 v110, 0
    v_mov_b32 v111, 0
    v_mov_b32 v112, 0
    v_mov_b32 v113, 0
    v_mov_b32 v114, 0
    v_mov_b32 v115, 0
    v_mov_b32 v116, 0
    v_mov_b32 v117, 0
    v_mov_b32 v118, 0
    v_mov_b32 v119, 0
    v_mov_b32 v120, 0
    v_mov_b32 v121, 0
    v_mov_b32 v122, 0
    v_mov_b32 v123, 0
    v_mov_b32 v124, 0
    v_mov_b32 v125, 0
    v_mov_b32 v126, 0
    v_mov_b32 v127, 0
    v_mov_b32 v128, 0
    v_mov_b32 v129, 0
    v_mov_b32 v130, 0
    v_mov_b32 v131, 0
    v_mov_b32 v132, 0
    v_mov_b32 v133, 0
    v_mov_b32 v134, 0
    v_mov_b32 v135, 0
    v_mov_b32 v136, 0
    v_mov_b32 v137, 0
    v_mov_b32 v138, 0
    v_mov_b32 v139, 0
    v_mov_b32 v140, 0
    v_mov_b32 v141, 0
    v_mov_b32 v142, 0
    v_mov_b32 v143, 0
    v_mov_b32 v144, 0
    v_mov_b32 v145, 0
    v_mov_b32 v146, 0
    v_mov_b32 v147, 0
    v_mov_b32 v148, 0
    v_mov_b32 v149, 0
    v_mov_b32 v150, 0
    v_mov_b32 v151, 0
    v_mov_b32 v152, 0
    v_mov_b32 v153, 0
    v_mov_b32 v154, 0
    v_mov_b32 v155, 0
    v_mov_b32 v156, 0
    v_mov_b32 v157, 0
    v_mov_b32 v158, 0
    v_mov_b32 v159, 0
    v_mov_b32 v160, 0
    v_mov_b32 v161, 0
    v_mov_b32 v162, 0
    v_mov_b32 v163, 0
    v_mov_b32 v164, 0
    v_mov_b32 v165, 0
    v_mov_b32 v166, 0
    v_mov_b32 v167, 0
    v_mov_b32 v168, 0
    v_mov_b32 v169, 0
    v_mov_b32 v170, 0
    v_mov_b32 v171, 0
    v_mov_b32 v172, 0
    v_mov_b32 v173, 0
    v_mov_b32 v174, 0
    v_mov_b32 v175, 0
    v_mov_b32 v176, 0
    v_mov_b32 v177, 0
    v_mov_b32 v178, 0
    v_mov_b32 v179, 0
    v_mov_b32 v180, 0
    v_mov_b32 v181, 0
    v_mov_b32 v182, 0
    v_mov_b32 v183, 0
    v_mov_b32 v184, 0
    v_mov_b32 v185, 0
    v_mov_b32 v186, 0
    v_mov_b32 v187, 0
    v_mov_b32 v188, 0
    v_mov_b32 v189, 0
    v_mov_b32 v190, 0
    v_mov_b32 v191, 0
    s_add_u32 s18, s23, 4096
    s_mov_b32 s21, 0
    s_mov_b32 s24, 0
    s_mov_b32 s16, 0
    s_mov_b32 s17, 65536
    s_mov_b32 s22, 49152
    v_mov_b32 v8, v5
    v_mov_b32 v10, v7
    v_xor_b32 v9, 32, v7

    s_barrier
    s_barrier
    s_cmp_eq_u32 s26, 0
    s_cbranch_scc1 k1_nopf_1
    buffer_load_dword v15, v13, s[64:67], s63 offen
    buffer_load_dword v15, v12, s[40:43], s62 offen
    buffer_load_dword v15, v13, s[8:11], s38 offen
    buffer_load_dword v15, v12, s[4:7], s37 offen

k1_nopf_1:
k1_common:
    s_cmp_eq_u32 s47, 1
    s_cbranch_scc0 k1_sel_ld
    s_cmp_eq_u32 s26, 0
    s_cbranch_scc1 k1_main_0_2
    s_branch k1_main_1_2

k1_sel_ld:
    s_cmp_eq_u32 s26, 0
    s_cbranch_scc1 k1_sel_0
    s_cmp_lt_u32 s29, 4
    s_cbranch_scc1 k1_main_1_0
    s_branch k1_main_1_1

k1_sel_0:
    s_cmp_ge_u32 s29, 4
    s_cbranch_scc1 k1_main_0_1

k1_main_0_0:

    s_waitcnt vmcnt(8)
    s_barrier

    ds_read_b128 v[16:19], v8 offset:0
    ds_read_b128 v[20:23], v8 offset:2048
    ds_read_b128 v[24:27], v8 offset:4096
    ds_read_b128 v[28:31], v8 offset:6144
    ds_read_b64_tr_b16 v[32:33], v10 offset:0
    ds_read_b64_tr_b16 v[34:35], v10 offset:512
    ds_read_b64_tr_b16 v[36:37], v9 offset:0
    ds_read_b64_tr_b16 v[38:39], v9 offset:512
    ds_read_b64_tr_b16 v[40:41], v10 offset:4096
    ds_read_b64_tr_b16 v[42:43], v10 offset:4608
    ds_read_b64_tr_b16 v[44:45], v9 offset:4096
    ds_read_b64_tr_b16 v[46:47], v9 offset:4608
    ds_read_b64_tr_b16 v[48:49], v10 offset:8192
    ds_read_b64_tr_b16 v[50:51], v10 offset:8704
    ds_read_b64_tr_b16 v[52:53], v9 offset:8192
    ds_read_b64_tr_b16 v[54:55], v9 offset:8704
    s_add_u32 s21, s21, 12288
    s_cmp_eq_u32 s21, 61440
    s_cselect_b32 s21, 0, s21
    v_add_u32 v10, s21, v7
    v_xor_b32 v9, 32, v10
    v_xor_b32 v8, 64, v8
k1_loop_0_0:
    s_waitcnt  lgkmcnt(0)
    s_barrier
    v_mfma_f32_16x16x32_bf16 v[96:99], v[32:35], v[16:19], v[96:99]
    s_add_u32 m0, s17, s23
    s_cmp_lt_u32 s24, 28
    s_cselect_b32 s6, s25, 0
    ds_read_b128 v[56:59], v8 offset:0
    v_mfma_f32_16x16x32_bf16 v[104:107], v[32:35], v[20:23], v[104:107]
    ds_read_b128 v[60:63], v8 offset:2048
    v_mfma_f32_16x16x32_bf16 v[144:147], v[32:35], v[24:27], v[144:147]
    ds_read_b128 v[64:67], v8 offset:4096
    buffer_load_dwordx4 v4, s[4:7], s62 offen offset:0 lds
    v_mfma_f32_16x16x32_bf16 v[152:155], v[32:35], v[28:31], v[152:155]
    ds_read_b128 v[68:71], v8 offset:6144
    v_mfma_f32_16x16x32_bf16 v[100:103], v[36:39], v[16:19], v[100:103]
    ds_read_b64_tr_b16 v[72:73], v10 offset:0
    v_mfma_f32_16x16x32_bf16 v[108:111], v[36:39], v[20:23], v[108:111]
    ds_read_b64_tr_b16 v[74:75], v10 offset:512
    v_mfma_f32_16x16x32_bf16 v[148:151], v[36:39], v[24:27], v[148:151]
    ds_read_b64_tr_b16 v[76:77], v9 offset:0
    v_mfma_f32_16x16x32_bf16 v[156:159], v[36:39], v[28:31], v[156:159]
    ds_read_b64_tr_b16 v[78:79], v9 offset:512
    v_mfma_f32_16x16x32_bf16 v[112:115], v[40:43], v[16:19], v[112:115]
    ds_read_b64_tr_b16 v[80:81], v10 offset:4096
    buffer_load_dwordx4 v6, s[4:7], s63 offen offset:1024 lds
    v_mfma_f32_16x16x32_bf16 v[120:123], v[40:43], v[20:23], v[120:123]
    ds_read_b64_tr_b16 v[82:83], v10 offset:4608
    v_mfma_f32_16x16x32_bf16 v[160:163], v[40:43], v[24:27], v[160:163]
    ds_read_b64_tr_b16 v[84:85], v9 offset:4096
    v_mfma_f32_16x16x32_bf16 v[168:171], v[40:43], v[28:31], v[168:171]
    ds_read_b64_tr_b16 v[86:87], v9 offset:4608
    v_mfma_f32_16x16x32_bf16 v[116:119], v[44:47], v[16:19], v[116:119]
    ds_read_b64_tr_b16 v[88:89], v10 offset:8192
    v_mfma_f32_16x16x32_bf16 v[124:127], v[44:47], v[20:23], v[124:127]
    ds_read_b64_tr_b16 v[90:91], v10 offset:8704
    v_mfma_f32_16x16x32_bf16 v[164:167], v[44:47], v[24:27], v[164:167]
    ds_read_b64_tr_b16 v[92:93], v9 offset:8192
    buffer_load_dwordx4 v4, s[4:7], s64 offen offset:2048 lds
    v_mfma_f32_16x16x32_bf16 v[172:175], v[44:47], v[28:31], v[172:175]
    ds_read_b64_tr_b16 v[94:95], v9 offset:8704
    s_add_u32 s21, s21, 12288
    s_cmp_eq_u32 s21, 61440
    s_cselect_b32 s21, 0, s21
    v_add_u32 v10, s21, v7
    v_xor_b32 v9, 32, v10
    s_add_u32 s16, s16, 32768
    s_cmp_eq_u32 s16, 98304
    s_cselect_b32 s16, 0, s16
    v_add_u32 v8, s16, v5
    s_add_u32 s24, s24, 1
    v_mfma_f32_16x16x32_bf16 v[128:131], v[16:19], v[48:51], v[128:131]
    v_mfma_f32_16x16x32_bf16 v[132:135], v[20:23], v[48:51], v[132:135]
    v_mfma_f32_16x16x32_bf16 v[176:179], v[24:27], v[48:51], v[176:179]
    v_mfma_f32_16x16x32_bf16 v[180:183], v[28:31], v[48:51], v[180:183]
    v_mfma_f32_16x16x32_bf16 v[136:139], v[16:19], v[52:55], v[136:139]
    buffer_load_dwordx4 v6, s[4:7], s65 offen offset:3072 lds
    v_mfma_f32_16x16x32_bf16 v[140:143], v[20:23], v[52:55], v[140:143]
    v_mfma_f32_16x16x32_bf16 v[184:187], v[24:27], v[52:55], v[184:187]
    v_mfma_f32_16x16x32_bf16 v[188:191], v[28:31], v[52:55], v[188:191]
    s_waitcnt vmcnt(4) lgkmcnt(0)
    s_barrier
    v_mfma_f32_16x16x32_bf16 v[96:99], v[72:75], v[56:59], v[96:99]
    s_add_u32 m0, s17, s18
    s_add_u32 s17, s17, 32768
    s_cmp_eq_u32 s17, 98304
    s_cselect_b32 s17, 0, s17
    s_cmp_lt_u32 s24, 28
    s_cselect_b32 s6, s25, 0
    ds_read_b128 v[16:19], v8 offset:0
    v_mfma_f32_16x16x32_bf16 v[104:107], v[72:75], v[60:63], v[104:107]
    ds_read_b128 v[20:23], v8 offset:2048
    v_mfma_f32_16x16x32_bf16 v[144:147], v[72:75], v[64:67], v[144:147]
    ds_read_b128 v[24:27], v8 offset:4096
    buffer_load_dwordx4 v4, s[4:7], s66 offen offset:0 lds
    v_mfma_f32_16x16x32_bf16 v[152:155], v[72:75], v[68:71], v[152:155]
    ds_read_b128 v[28:31], v8 offset:6144
    v_mfma_f32_16x16x32_bf16 v[100:103], v[76:79], v[56:59], v[100:103]
    ds_read_b64_tr_b16 v[32:33], v10 offset:0
    v_mfma_f32_16x16x32_bf16 v[108:111], v[76:79], v[60:63], v[108:111]
    ds_read_b64_tr_b16 v[34:35], v10 offset:512
    v_mfma_f32_16x16x32_bf16 v[148:151], v[76:79], v[64:67], v[148:151]
    ds_read_b64_tr_b16 v[36:37], v9 offset:0
    v_mfma_f32_16x16x32_bf16 v[156:159], v[76:79], v[68:71], v[156:159]
    ds_read_b64_tr_b16 v[38:39], v9 offset:512
    v_mfma_f32_16x16x32_bf16 v[112:115], v[80:83], v[56:59], v[112:115]
    ds_read_b64_tr_b16 v[40:41], v10 offset:4096
    buffer_load_dwordx4 v6, s[4:7], s67 offen offset:1024 lds
    v_mfma_f32_16x16x32_bf16 v[120:123], v[80:83], v[60:63], v[120:123]
    ds_read_b64_tr_b16 v[42:43], v10 offset:4608
    v_mfma_f32_16x16x32_bf16 v[160:163], v[80:83], v[64:67], v[160:163]
    ds_read_b64_tr_b16 v[44:45], v9 offset:4096
    v_mfma_f32_16x16x32_bf16 v[168:171], v[80:83], v[68:71], v[168:171]
    ds_read_b64_tr_b16 v[46:47], v9 offset:4608
    v_mfma_f32_16x16x32_bf16 v[116:119], v[84:87], v[56:59], v[116:119]
    ds_read_b64_tr_b16 v[48:49], v10 offset:8192
    v_mfma_f32_16x16x32_bf16 v[124:127], v[84:87], v[60:63], v[124:127]
    ds_read_b64_tr_b16 v[50:51], v10 offset:8704
    v_mfma_f32_16x16x32_bf16 v[164:167], v[84:87], v[64:67], v[164:167]
    ds_read_b64_tr_b16 v[52:53], v9 offset:8192
    buffer_load_dwordx4 v4, s[4:7], s68 offen offset:2048 lds
    v_mfma_f32_16x16x32_bf16 v[172:175], v[84:87], v[68:71], v[172:175]
    ds_read_b64_tr_b16 v[54:55], v9 offset:8704
    s_add_u32 s21, s21, 12288
    s_cmp_eq_u32 s21, 61440
    s_cselect_b32 s21, 0, s21
    v_add_u32 v10, s21, v7
    v_xor_b32 v9, 32, v10
    v_xor_b32 v8, 64, v8
    s_add_u32 s24, s24, 1
    v_mfma_f32_16x16x32_bf16 v[128:131], v[56:59], v[88:91], v[128:131]
    v_mfma_f32_16x16x32_bf16 v[132:135], v[60:63], v[88:91], v[132:135]
    v_mfma_f32_16x16x32_bf16 v[176:179], v[64:67], v[88:91], v[176:179]
    v_mfma_f32_16x16x32_bf16 v[180:183], v[68:71], v[88:91], v[180:183]
    v_mfma_f32_16x16x32_bf16 v[136:139], v[56:59], v[92:95], v[136:139]
    buffer_load_dwordx4 v6, s[4:7], s69 offen offset:3072 lds
    v_add_u32 v4, s39, v4
    v_add_u32 v6, s39, v6
    v_mfma_f32_16x16x32_bf16 v[140:143], v[60:63], v[92:95], v[140:143]
    v_mfma_f32_16x16x32_bf16 v[184:187], v[64:67], v[92:95], v[184:187]
    v_mfma_f32_16x16x32_bf16 v[188:191], v[68:71], v[92:95], v[188:191]
    s_cmp_lt_u32 s24, 28
    s_cbranch_scc1 k1_loop_0_0
    s_branch k1_tail_0
k1_main_0_1:

    s_waitcnt vmcnt(12)
    s_barrier

    ds_read_b128 v[16:19], v8 offset:0
    ds_read_b128 v[20:23], v8 offset:2048
    ds_read_b128 v[24:27], v8 offset:4096
    ds_read_b128 v[28:31], v8 offset:6144
    ds_read_b64_tr_b16 v[32:33], v10 offset:0
    ds_read_b64_tr_b16 v[34:35], v10 offset:512
    ds_read_b64_tr_b16 v[36:37], v9 offset:0
    ds_read_b64_tr_b16 v[38:39], v9 offset:512
    ds_read_b64_tr_b16 v[40:41], v10 offset:4096
    ds_read_b64_tr_b16 v[42:43], v10 offset:4608
    ds_read_b64_tr_b16 v[44:45], v9 offset:4096
    ds_read_b64_tr_b16 v[46:47], v9 offset:4608
    ds_read_b64_tr_b16 v[48:49], v10 offset:8192
    ds_read_b64_tr_b16 v[50:51], v10 offset:8704
    ds_read_b64_tr_b16 v[52:53], v9 offset:8192
    ds_read_b64_tr_b16 v[54:55], v9 offset:8704
    s_add_u32 s21, s21, 12288
    s_cmp_eq_u32 s21, 61440
    s_cselect_b32 s21, 0, s21
    v_add_u32 v10, s21, v7
    v_xor_b32 v9, 32, v10
    v_xor_b32 v8, 64, v8
k1_loop_0_1:
    s_waitcnt vmcnt(8) lgkmcnt(0)
    s_barrier
    v_mfma_f32_16x16x32_bf16 v[96:99], v[32:35], v[16:19], v[96:99]
    s_add_u32 m0, s22, s23
    s_add_u32 s22, s22, 12288
    s_cmp_eq_u32 s22, 61440
    s_cselect_b32 s22, 0, s22
    s_cmp_lt_u32 s24, 28
    s_cselect_b32 s6, s25, 0
    ds_read_b128 v[56:59], v8 offset:0
    v_mfma_f32_16x16x32_bf16 v[104:107], v[32:35], v[20:23], v[104:107]
    ds_read_b128 v[60:63], v8 offset:2048
    v_mfma_f32_16x16x32_bf16 v[144:147], v[32:35], v[24:27], v[144:147]
    ds_read_b128 v[64:67], v8 offset:4096
    v_mfma_f32_16x16x32_bf16 v[152:155], v[32:35], v[28:31], v[152:155]
    ds_read_b128 v[68:71], v8 offset:6144
    v_mfma_f32_16x16x32_bf16 v[100:103], v[36:39], v[16:19], v[100:103]
    ds_read_b64_tr_b16 v[72:73], v10 offset:0
    v_mfma_f32_16x16x32_bf16 v[108:111], v[36:39], v[20:23], v[108:111]
    ds_read_b64_tr_b16 v[74:75], v10 offset:512
    buffer_load_dwordx4 v4, s[4:7], s62 offen offset:0 lds
    v_mfma_f32_16x16x32_bf16 v[148:151], v[36:39], v[24:27], v[148:151]
    ds_read_b64_tr_b16 v[76:77], v9 offset:0
    v_mfma_f32_16x16x32_bf16 v[156:159], v[36:39], v[28:31], v[156:159]
    ds_read_b64_tr_b16 v[78:79], v9 offset:512
    v_mfma_f32_16x16x32_bf16 v[112:115], v[40:43], v[16:19], v[112:115]
    ds_read_b64_tr_b16 v[80:81], v10 offset:4096
    v_mfma_f32_16x16x32_bf16 v[120:123], v[40:43], v[20:23], v[120:123]
    ds_read_b64_tr_b16 v[82:83], v10 offset:4608
    v_mfma_f32_16x16x32_bf16 v[160:163], v[40:43], v[24:27], v[160:163]
    ds_read_b64_tr_b16 v[84:85], v9 offset:4096
    v_mfma_f32_16x16x32_bf16 v[168:171], v[40:43], v[28:31], v[168:171]
    ds_read_b64_tr_b16 v[86:87], v9 offset:4608
    buffer_load_dwordx4 v6, s[4:7], s63 offen offset:1024 lds
    v_mfma_f32_16x16x32_bf16 v[116:119], v[44:47], v[16:19], v[116:119]
    ds_read_b64_tr_b16 v[88:89], v10 offset:8192
    v_mfma_f32_16x16x32_bf16 v[124:127], v[44:47], v[20:23], v[124:127]
    ds_read_b64_tr_b16 v[90:91], v10 offset:8704
    v_mfma_f32_16x16x32_bf16 v[164:167], v[44:47], v[24:27], v[164:167]
    ds_read_b64_tr_b16 v[92:93], v9 offset:8192
    v_mfma_f32_16x16x32_bf16 v[172:175], v[44:47], v[28:31], v[172:175]
    ds_read_b64_tr_b16 v[94:95], v9 offset:8704
    s_add_u32 s21, s21, 12288
    s_cmp_eq_u32 s21, 61440
    s_cselect_b32 s21, 0, s21
    v_add_u32 v10, s21, v7
    v_xor_b32 v9, 32, v10
    s_add_u32 s16, s16, 32768
    s_cmp_eq_u32 s16, 98304
    s_cselect_b32 s16, 0, s16
    v_add_u32 v8, s16, v5
    s_add_u32 s24, s24, 1
    v_mfma_f32_16x16x32_bf16 v[128:131], v[16:19], v[48:51], v[128:131]
    v_mfma_f32_16x16x32_bf16 v[132:135], v[20:23], v[48:51], v[132:135]
    buffer_load_dwordx4 v4, s[4:7], s64 offen offset:2048 lds
    v_mfma_f32_16x16x32_bf16 v[176:179], v[24:27], v[48:51], v[176:179]
    v_mfma_f32_16x16x32_bf16 v[180:183], v[28:31], v[48:51], v[180:183]
    v_mfma_f32_16x16x32_bf16 v[136:139], v[16:19], v[52:55], v[136:139]
    v_mfma_f32_16x16x32_bf16 v[140:143], v[20:23], v[52:55], v[140:143]
    v_mfma_f32_16x16x32_bf16 v[184:187], v[24:27], v[52:55], v[184:187]
    buffer_load_dwordx4 v6, s[4:7], s65 offen offset:3072 lds
    v_mfma_f32_16x16x32_bf16 v[188:191], v[28:31], v[52:55], v[188:191]
    s_waitcnt vmcnt(8) lgkmcnt(0)
    s_barrier
    v_mfma_f32_16x16x32_bf16 v[96:99], v[72:75], v[56:59], v[96:99]
    s_add_u32 m0, s22, s23
    s_add_u32 s22, s22, 12288
    s_cmp_eq_u32 s22, 61440
    s_cselect_b32 s22, 0, s22
    s_cmp_lt_u32 s24, 28
    s_cselect_b32 s6, s25, 0
    ds_read_b128 v[16:19], v8 offset:0
    v_mfma_f32_16x16x32_bf16 v[104:107], v[72:75], v[60:63], v[104:107]
    ds_read_b128 v[20:23], v8 offset:2048
    v_mfma_f32_16x16x32_bf16 v[144:147], v[72:75], v[64:67], v[144:147]
    ds_read_b128 v[24:27], v8 offset:4096
    v_mfma_f32_16x16x32_bf16 v[152:155], v[72:75], v[68:71], v[152:155]
    ds_read_b128 v[28:31], v8 offset:6144
    v_mfma_f32_16x16x32_bf16 v[100:103], v[76:79], v[56:59], v[100:103]
    ds_read_b64_tr_b16 v[32:33], v10 offset:0
    v_mfma_f32_16x16x32_bf16 v[108:111], v[76:79], v[60:63], v[108:111]
    ds_read_b64_tr_b16 v[34:35], v10 offset:512
    buffer_load_dwordx4 v4, s[4:7], s66 offen offset:0 lds
    v_mfma_f32_16x16x32_bf16 v[148:151], v[76:79], v[64:67], v[148:151]
    ds_read_b64_tr_b16 v[36:37], v9 offset:0
    v_mfma_f32_16x16x32_bf16 v[156:159], v[76:79], v[68:71], v[156:159]
    ds_read_b64_tr_b16 v[38:39], v9 offset:512
    v_mfma_f32_16x16x32_bf16 v[112:115], v[80:83], v[56:59], v[112:115]
    ds_read_b64_tr_b16 v[40:41], v10 offset:4096
    v_mfma_f32_16x16x32_bf16 v[120:123], v[80:83], v[60:63], v[120:123]
    ds_read_b64_tr_b16 v[42:43], v10 offset:4608
    v_mfma_f32_16x16x32_bf16 v[160:163], v[80:83], v[64:67], v[160:163]
    ds_read_b64_tr_b16 v[44:45], v9 offset:4096
    v_mfma_f32_16x16x32_bf16 v[168:171], v[80:83], v[68:71], v[168:171]
    ds_read_b64_tr_b16 v[46:47], v9 offset:4608
    buffer_load_dwordx4 v6, s[4:7], s67 offen offset:1024 lds
    v_mfma_f32_16x16x32_bf16 v[116:119], v[84:87], v[56:59], v[116:119]
    ds_read_b64_tr_b16 v[48:49], v10 offset:8192
    v_mfma_f32_16x16x32_bf16 v[124:127], v[84:87], v[60:63], v[124:127]
    ds_read_b64_tr_b16 v[50:51], v10 offset:8704
    v_mfma_f32_16x16x32_bf16 v[164:167], v[84:87], v[64:67], v[164:167]
    ds_read_b64_tr_b16 v[52:53], v9 offset:8192
    v_mfma_f32_16x16x32_bf16 v[172:175], v[84:87], v[68:71], v[172:175]
    ds_read_b64_tr_b16 v[54:55], v9 offset:8704
    s_add_u32 s21, s21, 12288
    s_cmp_eq_u32 s21, 61440
    s_cselect_b32 s21, 0, s21
    v_add_u32 v10, s21, v7
    v_xor_b32 v9, 32, v10
    v_xor_b32 v8, 64, v8
    s_add_u32 s24, s24, 1
    v_mfma_f32_16x16x32_bf16 v[128:131], v[56:59], v[88:91], v[128:131]
    v_mfma_f32_16x16x32_bf16 v[132:135], v[60:63], v[88:91], v[132:135]
    buffer_load_dwordx4 v4, s[4:7], s68 offen offset:2048 lds
    v_mfma_f32_16x16x32_bf16 v[176:179], v[64:67], v[88:91], v[176:179]
    v_mfma_f32_16x16x32_bf16 v[180:183], v[68:71], v[88:91], v[180:183]
    v_mfma_f32_16x16x32_bf16 v[136:139], v[56:59], v[92:95], v[136:139]
    v_mfma_f32_16x16x32_bf16 v[140:143], v[60:63], v[92:95], v[140:143]
    v_mfma_f32_16x16x32_bf16 v[184:187], v[64:67], v[92:95], v[184:187]
    buffer_load_dwordx4 v6, s[4:7], s69 offen offset:3072 lds
    v_add_u32 v4, s39, v4
    v_add_u32 v6, s39, v6
    v_mfma_f32_16x16x32_bf16 v[188:191], v[68:71], v[92:95], v[188:191]
    s_cmp_lt_u32 s24, 28
    s_cbranch_scc1 k1_loop_0_1
    s_branch k1_tail_0
k1_main_0_2:

    s_barrier

    ds_read_b128 v[16:19], v8 offset:0
    ds_read_b128 v[20:23], v8 offset:2048
    ds_read_b128 v[24:27], v8 offset:4096
    ds_read_b128 v[28:31], v8 offset:6144
    ds_read_b64_tr_b16 v[32:33], v10 offset:0
    ds_read_b64_tr_b16 v[34:35], v10 offset:512
    ds_read_b64_tr_b16 v[36:37], v9 offset:0
    ds_read_b64_tr_b16 v[38:39], v9 offset:512
    ds_read_b64_tr_b16 v[40:41], v10 offset:4096
    ds_read_b64_tr_b16 v[42:43], v10 offset:4608
    ds_read_b64_tr_b16 v[44:45], v9 offset:4096
    ds_read_b64_tr_b16 v[46:47], v9 offset:4608
    ds_read_b64_tr_b16 v[48:49], v10 offset:8192
    ds_read_b64_tr_b16 v[50:51], v10 offset:8704
    ds_read_b64_tr_b16 v[52:53], v9 offset:8192
    ds_read_b64_tr_b16 v[54:55], v9 offset:8704
    s_add_u32 s21, s21, 12288
    s_cmp_eq_u32 s21, 61440
    s_cselect_b32 s21, 0, s21
    v_add_u32 v10, s21, v7
    v_xor_b32 v9, 32, v10
    v_xor_b32 v8, 64, v8
k1_loop_0_2:
    s_waitcnt  lgkmcnt(0)
    s_barrier
    v_mfma_f32_16x16x32_bf16 v[96:99], v[32:35], v[16:19], v[96:99]
    ds_read_b128 v[56:59], v8 offset:0
    v_mfma_f32_16x16x32_bf16 v[104:107], v[32:35], v[20:23], v[104:107]
    ds_read_b128 v[60:63], v8 offset:2048
    v_mfma_f32_16x16x32_bf16 v[144:147], v[32:35], v[24:27], v[144:147]
    ds_read_b128 v[64:67], v8 offset:4096
    v_mfma_f32_16x16x32_bf16 v[152:155], v[32:35], v[28:31], v[152:155]
    ds_read_b128 v[68:71], v8 offset:6144
    v_mfma_f32_16x16x32_bf16 v[100:103], v[36:39], v[16:19], v[100:103]
    ds_read_b64_tr_b16 v[72:73], v10 offset:0
    v_mfma_f32_16x16x32_bf16 v[108:111], v[36:39], v[20:23], v[108:111]
    ds_read_b64_tr_b16 v[74:75], v10 offset:512
    v_mfma_f32_16x16x32_bf16 v[148:151], v[36:39], v[24:27], v[148:151]
    ds_read_b64_tr_b16 v[76:77], v9 offset:0
    v_mfma_f32_16x16x32_bf16 v[156:159], v[36:39], v[28:31], v[156:159]
    ds_read_b64_tr_b16 v[78:79], v9 offset:512
    v_mfma_f32_16x16x32_bf16 v[112:115], v[40:43], v[16:19], v[112:115]
    ds_read_b64_tr_b16 v[80:81], v10 offset:4096
    v_mfma_f32_16x16x32_bf16 v[120:123], v[40:43], v[20:23], v[120:123]
    ds_read_b64_tr_b16 v[82:83], v10 offset:4608
    v_mfma_f32_16x16x32_bf16 v[160:163], v[40:43], v[24:27], v[160:163]
    ds_read_b64_tr_b16 v[84:85], v9 offset:4096
    v_mfma_f32_16x16x32_bf16 v[168:171], v[40:43], v[28:31], v[168:171]
    ds_read_b64_tr_b16 v[86:87], v9 offset:4608
    v_mfma_f32_16x16x32_bf16 v[116:119], v[44:47], v[16:19], v[116:119]
    ds_read_b64_tr_b16 v[88:89], v10 offset:8192
    v_mfma_f32_16x16x32_bf16 v[124:127], v[44:47], v[20:23], v[124:127]
    ds_read_b64_tr_b16 v[90:91], v10 offset:8704
    v_mfma_f32_16x16x32_bf16 v[164:167], v[44:47], v[24:27], v[164:167]
    ds_read_b64_tr_b16 v[92:93], v9 offset:8192
    v_mfma_f32_16x16x32_bf16 v[172:175], v[44:47], v[28:31], v[172:175]
    ds_read_b64_tr_b16 v[94:95], v9 offset:8704
    s_add_u32 s21, s21, 12288
    s_cmp_eq_u32 s21, 61440
    s_cselect_b32 s21, 0, s21
    v_add_u32 v10, s21, v7
    v_xor_b32 v9, 32, v10
    s_add_u32 s16, s16, 32768
    s_cmp_eq_u32 s16, 98304
    s_cselect_b32 s16, 0, s16
    v_add_u32 v8, s16, v5
    s_add_u32 s24, s24, 1
    v_mfma_f32_16x16x32_bf16 v[128:131], v[16:19], v[48:51], v[128:131]
    v_mfma_f32_16x16x32_bf16 v[132:135], v[20:23], v[48:51], v[132:135]
    v_mfma_f32_16x16x32_bf16 v[176:179], v[24:27], v[48:51], v[176:179]
    v_mfma_f32_16x16x32_bf16 v[180:183], v[28:31], v[48:51], v[180:183]
    v_mfma_f32_16x16x32_bf16 v[136:139], v[16:19], v[52:55], v[136:139]
    v_mfma_f32_16x16x32_bf16 v[140:143], v[20:23], v[52:55], v[140:143]
    v_mfma_f32_16x16x32_bf16 v[184:187], v[24:27], v[52:55], v[184:187]
    v_mfma_f32_16x16x32_bf16 v[188:191], v[28:31], v[52:55], v[188:191]
    s_waitcnt  lgkmcnt(0)
    s_barrier
    v_mfma_f32_16x16x32_bf16 v[96:99], v[72:75], v[56:59], v[96:99]
    ds_read_b128 v[16:19], v8 offset:0
    v_mfma_f32_16x16x32_bf16 v[104:107], v[72:75], v[60:63], v[104:107]
    ds_read_b128 v[20:23], v8 offset:2048
    v_mfma_f32_16x16x32_bf16 v[144:147], v[72:75], v[64:67], v[144:147]
    ds_read_b128 v[24:27], v8 offset:4096
    v_mfma_f32_16x16x32_bf16 v[152:155], v[72:75], v[68:71], v[152:155]
    ds_read_b128 v[28:31], v8 offset:6144
    v_mfma_f32_16x16x32_bf16 v[100:103], v[76:79], v[56:59], v[100:103]
    ds_read_b64_tr_b16 v[32:33], v10 offset:0
    v_mfma_f32_16x16x32_bf16 v[108:111], v[76:79], v[60:63], v[108:111]
    ds_read_b64_tr_b16 v[34:35], v10 offset:512
    v_mfma_f32_16x16x32_bf16 v[148:151], v[76:79], v[64:67], v[148:151]
    ds_read_b64_tr_b16 v[36:37], v9 offset:0
    s_cmp_eq_u32 s24, 25
    s_cbranch_scc1 k1_pfc_0
k1_pfc_back_0:
    v_mfma_f32_16x16x32_bf16 v[156:159], v[76:79], v[68:71], v[156:159]
    ds_read_b64_tr_b16 v[38:39], v9 offset:512
    v_mfma_f32_16x16x32_bf16 v[112:115], v[80:83], v[56:59], v[112:115]
    ds_read_b64_tr_b16 v[40:41], v10 offset:4096
    v_mfma_f32_16x16x32_bf16 v[120:123], v[80:83], v[60:63], v[120:123]
    ds_read_b64_tr_b16 v[42:43], v10 offset:4608
    v_mfma_f32_16x16x32_bf16 v[160:163], v[80:83], v[64:67], v[160:163]
    ds_read_b64_tr_b16 v[44:45], v9 offset:4096
    v_mfma_f32_16x16x32_bf16 v[168:171], v[80:83], v[68:71], v[168:171]
    ds_read_b64_tr_b16 v[46:47], v9 offset:4608
    v_mfma_f32_16x16x32_bf16 v[116:119], v[84:87], v[56:59], v[116:119]
    ds_read_b64_tr_b16 v[48:49], v10 offset:8192
    v_mfma_f32_16x16x32_bf16 v[124:127], v[84:87], v[60:63], v[124:127]
    ds_read_b64_tr_b16 v[50:51], v10 offset:8704
    v_mfma_f32_16x16x32_bf16 v[164:167], v[84:87], v[64:67], v[164:167]
    ds_read_b64_tr_b16 v[52:53], v9 offset:8192
    v_mfma_f32_16x16x32_bf16 v[172:175], v[84:87], v[68:71], v[172:175]
    ds_read_b64_tr_b16 v[54:55], v9 offset:8704
    s_add_u32 s21, s21, 12288
    s_cmp_eq_u32 s21, 61440
    s_cselect_b32 s21, 0, s21
    v_add_u32 v10, s21, v7
    v_xor_b32 v9, 32, v10
    v_xor_b32 v8, 64, v8
    s_add_u32 s24, s24, 1
    v_mfma_f32_16x16x32_bf16 v[128:131], v[56:59], v[88:91], v[128:131]
    v_mfma_f32_16x16x32_bf16 v[132:135], v[60:63], v[88:91], v[132:135]
    v_mfma_f32_16x16x32_bf16 v[176:179], v[64:67], v[88:91], v[176:179]
    v_mfma_f32_16x16x32_bf16 v[180:183], v[68:71], v[88:91], v[180:183]
    v_mfma_f32_16x16x32_bf16 v[136:139], v[56:59], v[92:95], v[136:139]
    v_mfma_f32_16x16x32_bf16 v[140:143], v[60:63], v[92:95], v[140:143]
    v_mfma_f32_16x16x32_bf16 v[184:187], v[64:67], v[92:95], v[184:187]
    v_mfma_f32_16x16x32_bf16 v[188:191], v[68:71], v[92:95], v[188:191]
    s_cmp_lt_u32 s24, 28
    s_cbranch_scc1 k1_loop_0_2
k1_tail_0:
    s_waitcnt vmcnt(8) lgkmcnt(0)
    s_barrier
    v_mfma_f32_16x16x32_bf16 v[96:99], v[32:35], v[16:19], v[96:99]
    ds_read_b128 v[56:59], v8 offset:0
    v_mfma_f32_16x16x32_bf16 v[104:107], v[32:35], v[20:23], v[104:107]
    ds_read_b128 v[60:63], v8 offset:2048
    v_mfma_f32_16x16x32_bf16 v[144:147], v[32:35], v[24:27], v[144:147]
    ds_read_b128 v[64:67], v8 offset:4096
    v_mfma_f32_16x16x32_bf16 v[152:155], v[32:35], v[28:31], v[152:155]
    ds_read_b128 v[68:71], v8 offset:6144
    v_mfma_f32_16x16x32_bf16 v[100:103], v[36:39], v[16:19], v[100:103]
    ds_read_b64_tr_b16 v[72:73], v10 offset:0
    v_mfma_f32_16x16x32_bf16 v[108:111], v[36:39], v[20:23], v[108:111]
    ds_read_b64_tr_b16 v[74:75], v10 offset:512
    v_mfma_f32_16x16x32_bf16 v[148:151], v[36:39], v[24:27], v[148:151]
    ds_read_b64_tr_b16 v[76:77], v9 offset:0
    v_mfma_f32_16x16x32_bf16 v[156:159], v[36:39], v[28:31], v[156:159]
    ds_read_b64_tr_b16 v[78:79], v9 offset:512
    v_mfma_f32_16x16x32_bf16 v[112:115], v[40:43], v[16:19], v[112:115]
    ds_read_b64_tr_b16 v[80:81], v10 offset:4096
    v_mfma_f32_16x16x32_bf16 v[120:123], v[40:43], v[20:23], v[120:123]
    ds_read_b64_tr_b16 v[82:83], v10 offset:4608
    v_mfma_f32_16x16x32_bf16 v[160:163], v[40:43], v[24:27], v[160:163]
    ds_read_b64_tr_b16 v[84:85], v9 offset:4096
    v_mfma_f32_16x16x32_bf16 v[168:171], v[40:43], v[28:31], v[168:171]
    ds_read_b64_tr_b16 v[86:87], v9 offset:4608
    v_mfma_f32_16x16x32_bf16 v[116:119], v[44:47], v[16:19], v[116:119]
    ds_read_b64_tr_b16 v[88:89], v10 offset:8192
    v_mfma_f32_16x16x32_bf16 v[124:127], v[44:47], v[20:23], v[124:127]
    ds_read_b64_tr_b16 v[90:91], v10 offset:8704
    v_mfma_f32_16x16x32_bf16 v[164:167], v[44:47], v[24:27], v[164:167]
    ds_read_b64_tr_b16 v[92:93], v9 offset:8192
    v_mfma_f32_16x16x32_bf16 v[172:175], v[44:47], v[28:31], v[172:175]
    ds_read_b64_tr_b16 v[94:95], v9 offset:8704
    s_add_u32 s21, s21, 12288
    s_cmp_eq_u32 s21, 61440
    s_cselect_b32 s21, 0, s21
    v_add_u32 v10, s21, v7
    v_xor_b32 v9, 32, v10
    s_add_u32 s16, s16, 32768
    s_cmp_eq_u32 s16, 98304
    s_cselect_b32 s16, 0, s16
    v_add_u32 v8, s16, v5
    v_mfma_f32_16x16x32_bf16 v[128:131], v[16:19], v[48:51], v[128:131]
    v_mfma_f32_16x16x32_bf16 v[132:135], v[20:23], v[48:51], v[132:135]
    v_mfma_f32_16x16x32_bf16 v[176:179], v[24:27], v[48:51], v[176:179]
    v_mfma_f32_16x16x32_bf16 v[180:183], v[28:31], v[48:51], v[180:183]
    v_mfma_f32_16x16x32_bf16 v[136:139], v[16:19], v[52:55], v[136:139]
    v_mfma_f32_16x16x32_bf16 v[140:143], v[20:23], v[52:55], v[140:143]
    v_mfma_f32_16x16x32_bf16 v[184:187], v[24:27], v[52:55], v[184:187]
    v_mfma_f32_16x16x32_bf16 v[188:191], v[28:31], v[52:55], v[188:191]
    s_cmp_eq_u32 s29, 7
    s_cbranch_scc1 k1_tail_a0
    s_waitcnt vmcnt(0)
k1_tail_a0:
    s_cmp_lt_u32 s29, 4
    s_cbranch_scc0 k1_tail_b0
    s_setprio 3
k1_tail_b0:
    s_waitcnt lgkmcnt(0)
    s_barrier
    v_mfma_f32_16x16x32_bf16 v[96:99], v[72:75], v[56:59], v[96:99]
    ds_read_b128 v[16:19], v8 offset:0
    v_mfma_f32_16x16x32_bf16 v[104:107], v[72:75], v[60:63], v[104:107]
    ds_read_b128 v[20:23], v8 offset:2048
    v_mfma_f32_16x16x32_bf16 v[144:147], v[72:75], v[64:67], v[144:147]
    ds_read_b128 v[24:27], v8 offset:4096
    v_mfma_f32_16x16x32_bf16 v[152:155], v[72:75], v[68:71], v[152:155]
    ds_read_b128 v[28:31], v8 offset:6144
    v_mfma_f32_16x16x32_bf16 v[100:103], v[76:79], v[56:59], v[100:103]
    ds_read_b64_tr_b16 v[32:33], v10 offset:0
    v_mfma_f32_16x16x32_bf16 v[108:111], v[76:79], v[60:63], v[108:111]
    ds_read_b64_tr_b16 v[34:35], v10 offset:512
    v_mfma_f32_16x16x32_bf16 v[148:151], v[76:79], v[64:67], v[148:151]
    ds_read_b64_tr_b16 v[36:37], v9 offset:0
    v_mfma_f32_16x16x32_bf16 v[156:159], v[76:79], v[68:71], v[156:159]
    ds_read_b64_tr_b16 v[38:39], v9 offset:512
    v_mfma_f32_16x16x32_bf16 v[112:115], v[80:83], v[56:59], v[112:115]
    ds_read_b64_tr_b16 v[40:41], v10 offset:4096
    v_mfma_f32_16x16x32_bf16 v[120:123], v[80:83], v[60:63], v[120:123]
    ds_read_b64_tr_b16 v[42:43], v10 offset:4608
    v_mfma_f32_16x16x32_bf16 v[160:163], v[80:83], v[64:67], v[160:163]
    ds_read_b64_tr_b16 v[44:45], v9 offset:4096
    v_mfma_f32_16x16x32_bf16 v[168:171], v[80:83], v[68:71], v[168:171]
    ds_read_b64_tr_b16 v[46:47], v9 offset:4608
    v_mfma_f32_16x16x32_bf16 v[116:119], v[84:87], v[56:59], v[116:119]
    ds_read_b64_tr_b16 v[48:49], v10 offset:8192
    v_mfma_f32_16x16x32_bf16 v[124:127], v[84:87], v[60:63], v[124:127]
    ds_read_b64_tr_b16 v[50:51], v10 offset:8704
    v_mfma_f32_16x16x32_bf16 v[164:167], v[84:87], v[64:67], v[164:167]
    ds_read_b64_tr_b16 v[52:53], v9 offset:8192
    v_mfma_f32_16x16x32_bf16 v[172:175], v[84:87], v[68:71], v[172:175]
    ds_read_b64_tr_b16 v[54:55], v9 offset:8704
    s_add_u32 s21, s21, 12288
    s_cmp_eq_u32 s21, 61440
    s_cselect_b32 s21, 0, s21
    v_add_u32 v10, s21, v7
    v_xor_b32 v9, 32, v10
    v_xor_b32 v8, 64, v8
    v_mfma_f32_16x16x32_bf16 v[128:131], v[56:59], v[88:91], v[128:131]
    v_mfma_f32_16x16x32_bf16 v[132:135], v[60:63], v[88:91], v[132:135]
    v_mfma_f32_16x16x32_bf16 v[176:179], v[64:67], v[88:91], v[176:179]
    v_mfma_f32_16x16x32_bf16 v[180:183], v[68:71], v[88:91], v[180:183]
    v_mfma_f32_16x16x32_bf16 v[136:139], v[56:59], v[92:95], v[136:139]
    v_mfma_f32_16x16x32_bf16 v[140:143], v[60:63], v[92:95], v[140:143]
    v_mfma_f32_16x16x32_bf16 v[184:187], v[64:67], v[92:95], v[184:187]
    v_mfma_f32_16x16x32_bf16 v[188:191], v[68:71], v[92:95], v[188:191]
    s_waitcnt lgkmcnt(0)
    v_mfma_f32_16x16x32_bf16 v[96:99], v[32:35], v[16:19], v[96:99]
    ds_read_b128 v[56:59], v8 offset:0
    v_mfma_f32_16x16x32_bf16 v[104:107], v[32:35], v[20:23], v[104:107]
    ds_read_b128 v[60:63], v8 offset:2048
    v_mfma_f32_16x16x32_bf16 v[144:147], v[32:35], v[24:27], v[144:147]
    ds_read_b128 v[64:67], v8 offset:4096
    v_mfma_f32_16x16x32_bf16 v[152:155], v[32:35], v[28:31], v[152:155]
    ds_read_b128 v[68:71], v8 offset:6144
    v_mfma_f32_16x16x32_bf16 v[100:103], v[36:39], v[16:19], v[100:103]
    ds_read_b64_tr_b16 v[72:73], v10 offset:0
    v_mfma_f32_16x16x32_bf16 v[108:111], v[36:39], v[20:23], v[108:111]
    ds_read_b64_tr_b16 v[74:75], v10 offset:512
    v_mfma_f32_16x16x32_bf16 v[148:151], v[36:39], v[24:27], v[148:151]
    ds_read_b64_tr_b16 v[76:77], v9 offset:0
    v_mfma_f32_16x16x32_bf16 v[156:159], v[36:39], v[28:31], v[156:159]
    ds_read_b64_tr_b16 v[78:79], v9 offset:512
    v_mfma_f32_16x16x32_bf16 v[112:115], v[40:43], v[16:19], v[112:115]
    ds_read_b64_tr_b16 v[80:81], v10 offset:4096
    v_mfma_f32_16x16x32_bf16 v[120:123], v[40:43], v[20:23], v[120:123]
    ds_read_b64_tr_b16 v[82:83], v10 offset:4608
    v_mfma_f32_16x16x32_bf16 v[160:163], v[40:43], v[24:27], v[160:163]
    ds_read_b64_tr_b16 v[84:85], v9 offset:4096
    v_mfma_f32_16x16x32_bf16 v[168:171], v[40:43], v[28:31], v[168:171]
    ds_read_b64_tr_b16 v[86:87], v9 offset:4608
    v_mfma_f32_16x16x32_bf16 v[116:119], v[44:47], v[16:19], v[116:119]
    ds_read_b64_tr_b16 v[88:89], v10 offset:8192
    v_mfma_f32_16x16x32_bf16 v[124:127], v[44:47], v[20:23], v[124:127]
    ds_read_b64_tr_b16 v[90:91], v10 offset:8704
    v_mfma_f32_16x16x32_bf16 v[164:167], v[44:47], v[24:27], v[164:167]
    ds_read_b64_tr_b16 v[92:93], v9 offset:8192
    v_mfma_f32_16x16x32_bf16 v[172:175], v[44:47], v[28:31], v[172:175]
    ds_read_b64_tr_b16 v[94:95], v9 offset:8704
    s_add_u32 s21, s21, 12288
    s_cmp_eq_u32 s21, 61440
    s_cselect_b32 s21, 0, s21
    v_add_u32 v10, s21, v7
    v_xor_b32 v9, 32, v10
    s_add_u32 s16, s16, 32768
    s_cmp_eq_u32 s16, 98304
    s_cselect_b32 s16, 0, s16
    v_add_u32 v8, s16, v5
    v_mfma_f32_16x16x32_bf16 v[128:131], v[16:19], v[48:51], v[128:131]
    v_mfma_f32_16x16x32_bf16 v[132:135], v[20:23], v[48:51], v[132:135]
    v_mfma_f32_16x16x32_bf16 v[176:179], v[24:27], v[48:51], v[176:179]
    v_mfma_f32_16x16x32_bf16 v[180:183], v[28:31], v[48:51], v[180:183]
    v_mfma_f32_16x16x32_bf16 v[136:139], v[16:19], v[52:55], v[136:139]
    v_mfma_f32_16x16x32_bf16 v[140:143], v[20:23], v[52:55], v[140:143]
    v_mfma_f32_16x16x32_bf16 v[184:187], v[24:27], v[52:55], v[184:187]
    v_mfma_f32_16x16x32_bf16 v[188:191], v[28:31], v[52:55], v[188:191]
    s_waitcnt lgkmcnt(0)
    v_mfma_f32_16x16x32_bf16 v[96:99], v[72:75], v[56:59], v[96:99]
    v_mfma_f32_16x16x32_bf16 v[104:107], v[72:75], v[60:63], v[104:107]
    v_mfma_f32_16x16x32_bf16 v[144:147], v[72:75], v[64:67], v[144:147]
    v_mfma_f32_16x16x32_bf16 v[152:155], v[72:75], v[68:71], v[152:155]
    v_mfma_f32_16x16x32_bf16 v[100:103], v[76:79], v[56:59], v[100:103]
    v_mfma_f32_16x16x32_bf16 v[108:111], v[76:79], v[60:63], v[108:111]
    v_mfma_f32_16x16x32_bf16 v[148:151], v[76:79], v[64:67], v[148:151]
    v_mfma_f32_16x16x32_bf16 v[156:159], v[76:79], v[68:71], v[156:159]
    v_mfma_f32_16x16x32_bf16 v[112:115], v[80:83], v[56:59], v[112:115]
    v_mfma_f32_16x16x32_bf16 v[120:123], v[80:83], v[60:63], v[120:123]
    v_mfma_f32_16x16x32_bf16 v[160:163], v[80:83], v[64:67], v[160:163]
    v_mfma_f32_16x16x32_bf16 v[168:171], v[80:83], v[68:71], v[168:171]
    v_mfma_f32_16x16x32_bf16 v[116:119], v[84:87], v[56:59], v[116:119]
    v_mfma_f32_16x16x32_bf16 v[124:127], v[84:87], v[60:63], v[124:127]
    v_mfma_f32_16x16x32_bf16 v[164:167], v[84:87], v[64:67], v[164:167]
    v_mfma_f32_16x16x32_bf16 v[172:175], v[84:87], v[68:71], v[172:175]
    v_mfma_f32_16x16x32_bf16 v[128:131], v[56:59], v[88:91], v[128:131]
    v_mfma_f32_16x16x32_bf16 v[132:135], v[60:63], v[88:91], v[132:135]
    v_mfma_f32_16x16x32_bf16 v[176:179], v[64:67], v[88:91], v[176:179]
    v_mfma_f32_16x16x32_bf16 v[180:183], v[68:71], v[88:91], v[180:183]
    v_mfma_f32_16x16x32_bf16 v[136:139], v[56:59], v[92:95], v[136:139]
    v_mfma_f32_16x16x32_bf16 v[140:143], v[60:63], v[92:95], v[140:143]
    v_mfma_f32_16x16x32_bf16 v[184:187], v[64:67], v[92:95], v[184:187]
    v_mfma_f32_16x16x32_bf16 v[188:191], v[68:71], v[92:95], v[188:191]
    s_branch k1_epi_0
k1_pfc_0:
    v_add_u32 v2, 8192, v14
    v_min_u32 v2, text_end-qkv_kernel-4, v2
    global_load_dword v15, v2, s[44:45]
    v_add_u32 v2, 16384, v14
    v_min_u32 v2, text_end-qkv_kernel-4, v2
    global_load_dword v15, v2, s[44:45]
    v_lshrrev_b32 v2, 2, v11
    v_mov_b32 v3, 0
    s_lshl_b32 s33, s2, 9
    s_add_u32 s33, s33, 31457280
    buffer_store_dword v3, v2, s[12:15], s33 offen sc1
    buffer_store_dword v3, v2, s[12:15], s33 offen offset:256 sc1
    s_branch k1_pfc_back_0
k1_main_1_0:

    s_waitcnt vmcnt(8)
    s_barrier

    ds_read_b128 v[16:19], v8 offset:0
    ds_read_b128 v[20:23], v8 offset:2048
    ds_read_b128 v[24:27], v8 offset:4096
    ds_read_b128 v[28:31], v8 offset:6144
    ds_read_b64_tr_b16 v[32:33], v10 offset:0
    ds_read_b64_tr_b16 v[34:35], v10 offset:512
    ds_read_b64_tr_b16 v[36:37], v9 offset:0
    ds_read_b64_tr_b16 v[38:39], v9 offset:512
    ds_read_b64_tr_b16 v[40:41], v10 offset:4096
    ds_read_b64_tr_b16 v[42:43], v10 offset:4608
    ds_read_b64_tr_b16 v[44:45], v9 offset:4096
    ds_read_b64_tr_b16 v[46:47], v9 offset:4608
    ds_read_b64_tr_b16 v[48:49], v10 offset:8192
    ds_read_b64_tr_b16 v[50:51], v10 offset:8704
    ds_read_b64_tr_b16 v[52:53], v9 offset:8192
    ds_read_b64_tr_b16 v[54:55], v9 offset:8704
    s_add_u32 s21, s21, 12288
    s_cmp_eq_u32 s21, 61440
    s_cselect_b32 s21, 0, s21
    v_add_u32 v10, s21, v7
    v_xor_b32 v9, 32, v10
    v_xor_b32 v8, 64, v8
k1_loop_1_0:
    s_waitcnt  lgkmcnt(0)
    s_barrier
    v_mfma_f32_16x16x32_bf16 v[96:99], v[32:35], v[16:19], v[96:99]
    s_add_u32 m0, s17, s23
    s_cmp_lt_u32 s24, 28
    s_cselect_b32 s6, s25, 0
    ds_read_b128 v[56:59], v8 offset:0
    v_mfma_f32_16x16x32_bf16 v[104:107], v[32:35], v[20:23], v[104:107]
    ds_read_b128 v[60:63], v8 offset:2048
    v_mfma_f32_16x16x32_bf16 v[144:147], v[32:35], v[24:27], v[144:147]
    ds_read_b128 v[64:67], v8 offset:4096
    buffer_load_dwordx4 v4, s[4:7], s62 offen offset:0 lds
    v_mfma_f32_16x16x32_bf16 v[152:155], v[32:35], v[28:31], v[152:155]
    ds_read_b128 v[68:71], v8 offset:6144
    v_mfma_f32_16x16x32_bf16 v[100:103], v[36:39], v[16:19], v[100:103]
    ds_read_b64_tr_b16 v[72:73], v10 offset:0
    v_mfma_f32_16x16x32_bf16 v[108:111], v[36:39], v[20:23], v[108:111]
    ds_read_b64_tr_b16 v[74:75], v10 offset:512
    v_mfma_f32_16x16x32_bf16 v[148:151], v[36:39], v[24:27], v[148:151]
    ds_read_b64_tr_b16 v[76:77], v9 offset:0
    v_mfma_f32_16x16x32_bf16 v[156:159], v[36:39], v[28:31], v[156:159]
    ds_read_b64_tr_b16 v[78:79], v9 offset:512
    v_mfma_f32_16x16x32_bf16 v[112:115], v[16:19], v[40:43], v[112:115]
    ds_read_b64_tr_b16 v[80:81], v10 offset:4096
    buffer_load_dwordx4 v6, s[4:7], s63 offen offset:1024 lds
    v_mfma_f32_16x16x32_bf16 v[116:119], v[20:23], v[40:43], v[116:119]
    ds_read_b64_tr_b16 v[82:83], v10 offset:4608
    v_mfma_f32_16x16x32_bf16 v[160:163], v[24:27], v[40:43], v[160:163]
    ds_read_b64_tr_b16 v[84:85], v9 offset:4096
    v_mfma_f32_16x16x32_bf16 v[164:167], v[28:31], v[40:43], v[164:167]
    ds_read_b64_tr_b16 v[86:87], v9 offset:4608
    v_mfma_f32_16x16x32_bf16 v[120:123], v[16:19], v[44:47], v[120:123]
    ds_read_b64_tr_b16 v[88:89], v10 offset:8192
    v_mfma_f32_16x16x32_bf16 v[124:127], v[20:23], v[44:47], v[124:127]
    ds_read_b64_tr_b16 v[90:91], v10 offset:8704
    v_mfma_f32_16x16x32_bf16 v[168:171], v[24:27], v[44:47], v[168:171]
    ds_read_b64_tr_b16 v[92:93], v9 offset:8192
    buffer_load_dwordx4 v4, s[4:7], s64 offen offset:2048 lds
    v_mfma_f32_16x16x32_bf16 v[172:175], v[28:31], v[44:47], v[172:175]
    ds_read_b64_tr_b16 v[94:95], v9 offset:8704
    s_add_u32 s21, s21, 12288
    s_cmp_eq_u32 s21, 61440
    s_cselect_b32 s21, 0, s21
    v_add_u32 v10, s21, v7
    v_xor_b32 v9, 32, v10
    s_add_u32 s16, s16, 32768
    s_cmp_eq_u32 s16, 98304
    s_cselect_b32 s16, 0, s16
    v_add_u32 v8, s16, v5
    s_add_u32 s24, s24, 1
    v_mfma_f32_16x16x32_bf16 v[128:131], v[16:19], v[48:51], v[128:131]
    v_mfma_f32_16x16x32_bf16 v[132:135], v[20:23], v[48:51], v[132:135]
    v_mfma_f32_16x16x32_bf16 v[176:179], v[24:27], v[48:51], v[176:179]
    v_mfma_f32_16x16x32_bf16 v[180:183], v[28:31], v[48:51], v[180:183]
    v_mfma_f32_16x16x32_bf16 v[136:139], v[16:19], v[52:55], v[136:139]
    buffer_load_dwordx4 v6, s[4:7], s65 offen offset:3072 lds
    v_mfma_f32_16x16x32_bf16 v[140:143], v[20:23], v[52:55], v[140:143]
    v_mfma_f32_16x16x32_bf16 v[184:187], v[24:27], v[52:55], v[184:187]
    v_mfma_f32_16x16x32_bf16 v[188:191], v[28:31], v[52:55], v[188:191]
    s_waitcnt vmcnt(4) lgkmcnt(0)
    s_barrier
    v_mfma_f32_16x16x32_bf16 v[96:99], v[72:75], v[56:59], v[96:99]
    s_add_u32 m0, s17, s18
    s_add_u32 s17, s17, 32768
    s_cmp_eq_u32 s17, 98304
    s_cselect_b32 s17, 0, s17
    s_cmp_lt_u32 s24, 28
    s_cselect_b32 s6, s25, 0
    ds_read_b128 v[16:19], v8 offset:0
    v_mfma_f32_16x16x32_bf16 v[104:107], v[72:75], v[60:63], v[104:107]
    ds_read_b128 v[20:23], v8 offset:2048
    v_mfma_f32_16x16x32_bf16 v[144:147], v[72:75], v[64:67], v[144:147]
    ds_read_b128 v[24:27], v8 offset:4096
    buffer_load_dwordx4 v4, s[4:7], s66 offen offset:0 lds
    v_mfma_f32_16x16x32_bf16 v[152:155], v[72:75], v[68:71], v[152:155]
    ds_read_b128 v[28:31], v8 offset:6144
    v_mfma_f32_16x16x32_bf16 v[100:103], v[76:79], v[56:59], v[100:103]
    ds_read_b64_tr_b16 v[32:33], v10 offset:0
    v_mfma_f32_16x16x32_bf16 v[108:111], v[76:79], v[60:63], v[108:111]
    ds_read_b64_tr_b16 v[34:35], v10 offset:512
    v_mfma_f32_16x16x32_bf16 v[148:151], v[76:79], v[64:67], v[148:151]
    ds_read_b64_tr_b16 v[36:37], v9 offset:0
    v_mfma_f32_16x16x32_bf16 v[156:159], v[76:79], v[68:71], v[156:159]
    ds_read_b64_tr_b16 v[38:39], v9 offset:512
    v_mfma_f32_16x16x32_bf16 v[112:115], v[56:59], v[80:83], v[112:115]
    ds_read_b64_tr_b16 v[40:41], v10 offset:4096
    buffer_load_dwordx4 v6, s[4:7], s67 offen offset:1024 lds
    v_mfma_f32_16x16x32_bf16 v[116:119], v[60:63], v[80:83], v[116:119]
    ds_read_b64_tr_b16 v[42:43], v10 offset:4608
    v_mfma_f32_16x16x32_bf16 v[160:163], v[64:67], v[80:83], v[160:163]
    ds_read_b64_tr_b16 v[44:45], v9 offset:4096
    v_mfma_f32_16x16x32_bf16 v[164:167], v[68:71], v[80:83], v[164:167]
    ds_read_b64_tr_b16 v[46:47], v9 offset:4608
    v_mfma_f32_16x16x32_bf16 v[120:123], v[56:59], v[84:87], v[120:123]
    ds_read_b64_tr_b16 v[48:49], v10 offset:8192
    v_mfma_f32_16x16x32_bf16 v[124:127], v[60:63], v[84:87], v[124:127]
    ds_read_b64_tr_b16 v[50:51], v10 offset:8704
    v_mfma_f32_16x16x32_bf16 v[168:171], v[64:67], v[84:87], v[168:171]
    ds_read_b64_tr_b16 v[52:53], v9 offset:8192
    buffer_load_dwordx4 v4, s[4:7], s68 offen offset:2048 lds
    v_mfma_f32_16x16x32_bf16 v[172:175], v[68:71], v[84:87], v[172:175]
    ds_read_b64_tr_b16 v[54:55], v9 offset:8704
    s_add_u32 s21, s21, 12288
    s_cmp_eq_u32 s21, 61440
    s_cselect_b32 s21, 0, s21
    v_add_u32 v10, s21, v7
    v_xor_b32 v9, 32, v10
    v_xor_b32 v8, 64, v8
    s_add_u32 s24, s24, 1
    v_mfma_f32_16x16x32_bf16 v[128:131], v[56:59], v[88:91], v[128:131]
    v_mfma_f32_16x16x32_bf16 v[132:135], v[60:63], v[88:91], v[132:135]
    v_mfma_f32_16x16x32_bf16 v[176:179], v[64:67], v[88:91], v[176:179]
    v_mfma_f32_16x16x32_bf16 v[180:183], v[68:71], v[88:91], v[180:183]
    v_mfma_f32_16x16x32_bf16 v[136:139], v[56:59], v[92:95], v[136:139]
    buffer_load_dwordx4 v6, s[4:7], s69 offen offset:3072 lds
    v_add_u32 v4, s39, v4
    v_add_u32 v6, s39, v6
    v_mfma_f32_16x16x32_bf16 v[140:143], v[60:63], v[92:95], v[140:143]
    v_mfma_f32_16x16x32_bf16 v[184:187], v[64:67], v[92:95], v[184:187]
    v_mfma_f32_16x16x32_bf16 v[188:191], v[68:71], v[92:95], v[188:191]
    s_cmp_lt_u32 s24, 28
    s_cbranch_scc1 k1_loop_1_0
    s_branch k1_tail_1
k1_main_1_1:

    s_waitcnt vmcnt(12)
    s_barrier

    ds_read_b128 v[16:19], v8 offset:0
    ds_read_b128 v[20:23], v8 offset:2048
    ds_read_b128 v[24:27], v8 offset:4096
    ds_read_b128 v[28:31], v8 offset:6144
    ds_read_b64_tr_b16 v[32:33], v10 offset:0
    ds_read_b64_tr_b16 v[34:35], v10 offset:512
    ds_read_b64_tr_b16 v[36:37], v9 offset:0
    ds_read_b64_tr_b16 v[38:39], v9 offset:512
    ds_read_b64_tr_b16 v[40:41], v10 offset:4096
    ds_read_b64_tr_b16 v[42:43], v10 offset:4608
    ds_read_b64_tr_b16 v[44:45], v9 offset:4096
    ds_read_b64_tr_b16 v[46:47], v9 offset:4608
    ds_read_b64_tr_b16 v[48:49], v10 offset:8192
    ds_read_b64_tr_b16 v[50:51], v10 offset:8704
    ds_read_b64_tr_b16 v[52:53], v9 offset:8192
    ds_read_b64_tr_b16 v[54:55], v9 offset:8704
    s_add_u32 s21, s21, 12288
    s_cmp_eq_u32 s21, 61440
    s_cselect_b32 s21, 0, s21
    v_add_u32 v10, s21, v7
    v_xor_b32 v9, 32, v10
    v_xor_b32 v8, 64, v8
k1_loop_1_1:
    s_waitcnt vmcnt(8) lgkmcnt(0)
    s_barrier
    v_mfma_f32_16x16x32_bf16 v[96:99], v[32:35], v[16:19], v[96:99]
    s_add_u32 m0, s22, s23
    s_add_u32 s22, s22, 12288
    s_cmp_eq_u32 s22, 61440
    s_cselect_b32 s22, 0, s22
    s_cmp_lt_u32 s24, 28
    s_cselect_b32 s6, s25, 0
    ds_read_b128 v[56:59], v8 offset:0
    v_mfma_f32_16x16x32_bf16 v[104:107], v[32:35], v[20:23], v[104:107]
    ds_read_b128 v[60:63], v8 offset:2048
    v_mfma_f32_16x16x32_bf16 v[144:147], v[32:35], v[24:27], v[144:147]
    ds_read_b128 v[64:67], v8 offset:4096
    v_mfma_f32_16x16x32_bf16 v[152:155], v[32:35], v[28:31], v[152:155]
    ds_read_b128 v[68:71], v8 offset:6144
    v_mfma_f32_16x16x32_bf16 v[100:103], v[36:39], v[16:19], v[100:103]
    ds_read_b64_tr_b16 v[72:73], v10 offset:0
    v_mfma_f32_16x16x32_bf16 v[108:111], v[36:39], v[20:23], v[108:111]
    ds_read_b64_tr_b16 v[74:75], v10 offset:512
    buffer_load_dwordx4 v4, s[4:7], s62 offen offset:0 lds
    v_mfma_f32_16x16x32_bf16 v[148:151], v[36:39], v[24:27], v[148:151]
    ds_read_b64_tr_b16 v[76:77], v9 offset:0
    v_mfma_f32_16x16x32_bf16 v[156:159], v[36:39], v[28:31], v[156:159]
    ds_read_b64_tr_b16 v[78:79], v9 offset:512
    v_mfma_f32_16x16x32_bf16 v[112:115], v[16:19], v[40:43], v[112:115]
    ds_read_b64_tr_b16 v[80:81], v10 offset:4096
    v_mfma_f32_16x16x32_bf16 v[116:119], v[20:23], v[40:43], v[116:119]
    ds_read_b64_tr_b16 v[82:83], v10 offset:4608
    v_mfma_f32_16x16x32_bf16 v[160:163], v[24:27], v[40:43], v[160:163]
    ds_read_b64_tr_b16 v[84:85], v9 offset:4096
    v_mfma_f32_16x16x32_bf16 v[164:167], v[28:31], v[40:43], v[164:167]
    ds_read_b64_tr_b16 v[86:87], v9 offset:4608
    buffer_load_dwordx4 v6, s[4:7], s63 offen offset:1024 lds
    v_mfma_f32_16x16x32_bf16 v[120:123], v[16:19], v[44:47], v[120:123]
    ds_read_b64_tr_b16 v[88:89], v10 offset:8192
    v_mfma_f32_16x16x32_bf16 v[124:127], v[20:23], v[44:47], v[124:127]
    ds_read_b64_tr_b16 v[90:91], v10 offset:8704
    v_mfma_f32_16x16x32_bf16 v[168:171], v[24:27], v[44:47], v[168:171]
    ds_read_b64_tr_b16 v[92:93], v9 offset:8192
    v_mfma_f32_16x16x32_bf16 v[172:175], v[28:31], v[44:47], v[172:175]
    ds_read_b64_tr_b16 v[94:95], v9 offset:8704
    s_add_u32 s21, s21, 12288
    s_cmp_eq_u32 s21, 61440
    s_cselect_b32 s21, 0, s21
    v_add_u32 v10, s21, v7
    v_xor_b32 v9, 32, v10
    s_add_u32 s16, s16, 32768
    s_cmp_eq_u32 s16, 98304
    s_cselect_b32 s16, 0, s16
    v_add_u32 v8, s16, v5
    s_add_u32 s24, s24, 1
    v_mfma_f32_16x16x32_bf16 v[128:131], v[16:19], v[48:51], v[128:131]
    v_mfma_f32_16x16x32_bf16 v[132:135], v[20:23], v[48:51], v[132:135]
    buffer_load_dwordx4 v4, s[4:7], s64 offen offset:2048 lds
    v_mfma_f32_16x16x32_bf16 v[176:179], v[24:27], v[48:51], v[176:179]
    v_mfma_f32_16x16x32_bf16 v[180:183], v[28:31], v[48:51], v[180:183]
    v_mfma_f32_16x16x32_bf16 v[136:139], v[16:19], v[52:55], v[136:139]
    v_mfma_f32_16x16x32_bf16 v[140:143], v[20:23], v[52:55], v[140:143]
    v_mfma_f32_16x16x32_bf16 v[184:187], v[24:27], v[52:55], v[184:187]
    buffer_load_dwordx4 v6, s[4:7], s65 offen offset:3072 lds
    v_mfma_f32_16x16x32_bf16 v[188:191], v[28:31], v[52:55], v[188:191]
    s_waitcnt vmcnt(8) lgkmcnt(0)
    s_barrier
    v_mfma_f32_16x16x32_bf16 v[96:99], v[72:75], v[56:59], v[96:99]
    s_add_u32 m0, s22, s23
    s_add_u32 s22, s22, 12288
    s_cmp_eq_u32 s22, 61440
    s_cselect_b32 s22, 0, s22
    s_cmp_lt_u32 s24, 28
    s_cselect_b32 s6, s25, 0
    ds_read_b128 v[16:19], v8 offset:0
    v_mfma_f32_16x16x32_bf16 v[104:107], v[72:75], v[60:63], v[104:107]
    ds_read_b128 v[20:23], v8 offset:2048
    v_mfma_f32_16x16x32_bf16 v[144:147], v[72:75], v[64:67], v[144:147]
    ds_read_b128 v[24:27], v8 offset:4096
    v_mfma_f32_16x16x32_bf16 v[152:155], v[72:75], v[68:71], v[152:155]
    ds_read_b128 v[28:31], v8 offset:6144
    v_mfma_f32_16x16x32_bf16 v[100:103], v[76:79], v[56:59], v[100:103]
    ds_read_b64_tr_b16 v[32:33], v10 offset:0
    v_mfma_f32_16x16x32_bf16 v[108:111], v[76:79], v[60:63], v[108:111]
    ds_read_b64_tr_b16 v[34:35], v10 offset:512
    buffer_load_dwordx4 v4, s[4:7], s66 offen offset:0 lds
    v_mfma_f32_16x16x32_bf16 v[148:151], v[76:79], v[64:67], v[148:151]
    ds_read_b64_tr_b16 v[36:37], v9 offset:0
    v_mfma_f32_16x16x32_bf16 v[156:159], v[76:79], v[68:71], v[156:159]
    ds_read_b64_tr_b16 v[38:39], v9 offset:512
    v_mfma_f32_16x16x32_bf16 v[112:115], v[56:59], v[80:83], v[112:115]
    ds_read_b64_tr_b16 v[40:41], v10 offset:4096
    v_mfma_f32_16x16x32_bf16 v[116:119], v[60:63], v[80:83], v[116:119]
    ds_read_b64_tr_b16 v[42:43], v10 offset:4608
    v_mfma_f32_16x16x32_bf16 v[160:163], v[64:67], v[80:83], v[160:163]
    ds_read_b64_tr_b16 v[44:45], v9 offset:4096
    v_mfma_f32_16x16x32_bf16 v[164:167], v[68:71], v[80:83], v[164:167]
    ds_read_b64_tr_b16 v[46:47], v9 offset:4608
    buffer_load_dwordx4 v6, s[4:7], s67 offen offset:1024 lds
    v_mfma_f32_16x16x32_bf16 v[120:123], v[56:59], v[84:87], v[120:123]
    ds_read_b64_tr_b16 v[48:49], v10 offset:8192
    v_mfma_f32_16x16x32_bf16 v[124:127], v[60:63], v[84:87], v[124:127]
    ds_read_b64_tr_b16 v[50:51], v10 offset:8704
    v_mfma_f32_16x16x32_bf16 v[168:171], v[64:67], v[84:87], v[168:171]
    ds_read_b64_tr_b16 v[52:53], v9 offset:8192
    v_mfma_f32_16x16x32_bf16 v[172:175], v[68:71], v[84:87], v[172:175]
    ds_read_b64_tr_b16 v[54:55], v9 offset:8704
    s_add_u32 s21, s21, 12288
    s_cmp_eq_u32 s21, 61440
    s_cselect_b32 s21, 0, s21
    v_add_u32 v10, s21, v7
    v_xor_b32 v9, 32, v10
    v_xor_b32 v8, 64, v8
    s_add_u32 s24, s24, 1
    v_mfma_f32_16x16x32_bf16 v[128:131], v[56:59], v[88:91], v[128:131]
    v_mfma_f32_16x16x32_bf16 v[132:135], v[60:63], v[88:91], v[132:135]
    buffer_load_dwordx4 v4, s[4:7], s68 offen offset:2048 lds
    v_mfma_f32_16x16x32_bf16 v[176:179], v[64:67], v[88:91], v[176:179]
    v_mfma_f32_16x16x32_bf16 v[180:183], v[68:71], v[88:91], v[180:183]
    v_mfma_f32_16x16x32_bf16 v[136:139], v[56:59], v[92:95], v[136:139]
    v_mfma_f32_16x16x32_bf16 v[140:143], v[60:63], v[92:95], v[140:143]
    v_mfma_f32_16x16x32_bf16 v[184:187], v[64:67], v[92:95], v[184:187]
    buffer_load_dwordx4 v6, s[4:7], s69 offen offset:3072 lds
    v_add_u32 v4, s39, v4
    v_add_u32 v6, s39, v6
    v_mfma_f32_16x16x32_bf16 v[188:191], v[68:71], v[92:95], v[188:191]
    s_cmp_lt_u32 s24, 28
    s_cbranch_scc1 k1_loop_1_1
    s_branch k1_tail_1
k1_main_1_2:

    s_barrier

    ds_read_b128 v[16:19], v8 offset:0
    ds_read_b128 v[20:23], v8 offset:2048
    ds_read_b128 v[24:27], v8 offset:4096
    ds_read_b128 v[28:31], v8 offset:6144
    ds_read_b64_tr_b16 v[32:33], v10 offset:0
    ds_read_b64_tr_b16 v[34:35], v10 offset:512
    ds_read_b64_tr_b16 v[36:37], v9 offset:0
    ds_read_b64_tr_b16 v[38:39], v9 offset:512
    ds_read_b64_tr_b16 v[40:41], v10 offset:4096
    ds_read_b64_tr_b16 v[42:43], v10 offset:4608
    ds_read_b64_tr_b16 v[44:45], v9 offset:4096
    ds_read_b64_tr_b16 v[46:47], v9 offset:4608
    ds_read_b64_tr_b16 v[48:49], v10 offset:8192
    ds_read_b64_tr_b16 v[50:51], v10 offset:8704
    ds_read_b64_tr_b16 v[52:53], v9 offset:8192
    ds_read_b64_tr_b16 v[54:55], v9 offset:8704
    s_add_u32 s21, s21, 12288
    s_cmp_eq_u32 s21, 61440
    s_cselect_b32 s21, 0, s21
    v_add_u32 v10, s21, v7
    v_xor_b32 v9, 32, v10
    v_xor_b32 v8, 64, v8
k1_loop_1_2:
    s_waitcnt  lgkmcnt(0)
    s_barrier
    v_mfma_f32_16x16x32_bf16 v[96:99], v[32:35], v[16:19], v[96:99]
    ds_read_b128 v[56:59], v8 offset:0
    v_mfma_f32_16x16x32_bf16 v[104:107], v[32:35], v[20:23], v[104:107]
    ds_read_b128 v[60:63], v8 offset:2048
    v_mfma_f32_16x16x32_bf16 v[144:147], v[32:35], v[24:27], v[144:147]
    ds_read_b128 v[64:67], v8 offset:4096
    v_mfma_f32_16x16x32_bf16 v[152:155], v[32:35], v[28:31], v[152:155]
    ds_read_b128 v[68:71], v8 offset:6144
    v_mfma_f32_16x16x32_bf16 v[100:103], v[36:39], v[16:19], v[100:103]
    ds_read_b64_tr_b16 v[72:73], v10 offset:0
    v_mfma_f32_16x16x32_bf16 v[108:111], v[36:39], v[20:23], v[108:111]
    ds_read_b64_tr_b16 v[74:75], v10 offset:512
    v_mfma_f32_16x16x32_bf16 v[148:151], v[36:39], v[24:27], v[148:151]
    ds_read_b64_tr_b16 v[76:77], v9 offset:0
    v_mfma_f32_16x16x32_bf16 v[156:159], v[36:39], v[28:31], v[156:159]
    ds_read_b64_tr_b16 v[78:79], v9 offset:512
    v_mfma_f32_16x16x32_bf16 v[112:115], v[16:19], v[40:43], v[112:115]
    ds_read_b64_tr_b16 v[80:81], v10 offset:4096
    v_mfma_f32_16x16x32_bf16 v[116:119], v[20:23], v[40:43], v[116:119]
    ds_read_b64_tr_b16 v[82:83], v10 offset:4608
    v_mfma_f32_16x16x32_bf16 v[160:163], v[24:27], v[40:43], v[160:163]
    ds_read_b64_tr_b16 v[84:85], v9 offset:4096
    v_mfma_f32_16x16x32_bf16 v[164:167], v[28:31], v[40:43], v[164:167]
    ds_read_b64_tr_b16 v[86:87], v9 offset:4608
    v_mfma_f32_16x16x32_bf16 v[120:123], v[16:19], v[44:47], v[120:123]
    ds_read_b64_tr_b16 v[88:89], v10 offset:8192
    v_mfma_f32_16x16x32_bf16 v[124:127], v[20:23], v[44:47], v[124:127]
    ds_read_b64_tr_b16 v[90:91], v10 offset:8704
    v_mfma_f32_16x16x32_bf16 v[168:171], v[24:27], v[44:47], v[168:171]
    ds_read_b64_tr_b16 v[92:93], v9 offset:8192
    v_mfma_f32_16x16x32_bf16 v[172:175], v[28:31], v[44:47], v[172:175]
    ds_read_b64_tr_b16 v[94:95], v9 offset:8704
    s_add_u32 s21, s21, 12288
    s_cmp_eq_u32 s21, 61440
    s_cselect_b32 s21, 0, s21
    v_add_u32 v10, s21, v7
    v_xor_b32 v9, 32, v10
    s_add_u32 s16, s16, 32768
    s_cmp_eq_u32 s16, 98304
    s_cselect_b32 s16, 0, s16
    v_add_u32 v8, s16, v5
    s_add_u32 s24, s24, 1
    v_mfma_f32_16x16x32_bf16 v[128:131], v[16:19], v[48:51], v[128:131]
    v_mfma_f32_16x16x32_bf16 v[132:135], v[20:23], v[48:51], v[132:135]
    v_mfma_f32_16x16x32_bf16 v[176:179], v[24:27], v[48:51], v[176:179]
    v_mfma_f32_16x16x32_bf16 v[180:183], v[28:31], v[48:51], v[180:183]
    v_mfma_f32_16x16x32_bf16 v[136:139], v[16:19], v[52:55], v[136:139]
    v_mfma_f32_16x16x32_bf16 v[140:143], v[20:23], v[52:55], v[140:143]
    v_mfma_f32_16x16x32_bf16 v[184:187], v[24:27], v[52:55], v[184:187]
    v_mfma_f32_16x16x32_bf16 v[188:191], v[28:31], v[52:55], v[188:191]
    s_waitcnt  lgkmcnt(0)
    s_barrier
    v_mfma_f32_16x16x32_bf16 v[96:99], v[72:75], v[56:59], v[96:99]
    ds_read_b128 v[16:19], v8 offset:0
    v_mfma_f32_16x16x32_bf16 v[104:107], v[72:75], v[60:63], v[104:107]
    ds_read_b128 v[20:23], v8 offset:2048
    v_mfma_f32_16x16x32_bf16 v[144:147], v[72:75], v[64:67], v[144:147]
    ds_read_b128 v[24:27], v8 offset:4096
    v_mfma_f32_16x16x32_bf16 v[152:155], v[72:75], v[68:71], v[152:155]
    ds_read_b128 v[28:31], v8 offset:6144
    v_mfma_f32_16x16x32_bf16 v[100:103], v[76:79], v[56:59], v[100:103]
    ds_read_b64_tr_b16 v[32:33], v10 offset:0
    v_mfma_f32_16x16x32_bf16 v[108:111], v[76:79], v[60:63], v[108:111]
    ds_read_b64_tr_b16 v[34:35], v10 offset:512
    v_mfma_f32_16x16x32_bf16 v[148:151], v[76:79], v[64:67], v[148:151]
    ds_read_b64_tr_b16 v[36:37], v9 offset:0
    s_cmp_eq_u32 s24, 25
    s_cbranch_scc1 k1_pfc_1
k1_pfc_back_1:
    v_mfma_f32_16x16x32_bf16 v[156:159], v[76:79], v[68:71], v[156:159]
    ds_read_b64_tr_b16 v[38:39], v9 offset:512
    v_mfma_f32_16x16x32_bf16 v[112:115], v[56:59], v[80:83], v[112:115]
    ds_read_b64_tr_b16 v[40:41], v10 offset:4096
    v_mfma_f32_16x16x32_bf16 v[116:119], v[60:63], v[80:83], v[116:119]
    ds_read_b64_tr_b16 v[42:43], v10 offset:4608
    v_mfma_f32_16x16x32_bf16 v[160:163], v[64:67], v[80:83], v[160:163]
    ds_read_b64_tr_b16 v[44:45], v9 offset:4096
    v_mfma_f32_16x16x32_bf16 v[164:167], v[68:71], v[80:83], v[164:167]
    ds_read_b64_tr_b16 v[46:47], v9 offset:4608
    v_mfma_f32_16x16x32_bf16 v[120:123], v[56:59], v[84:87], v[120:123]
    ds_read_b64_tr_b16 v[48:49], v10 offset:8192
    v_mfma_f32_16x16x32_bf16 v[124:127], v[60:63], v[84:87], v[124:127]
    ds_read_b64_tr_b16 v[50:51], v10 offset:8704
    v_mfma_f32_16x16x32_bf16 v[168:171], v[64:67], v[84:87], v[168:171]
    ds_read_b64_tr_b16 v[52:53], v9 offset:8192
    v_mfma_f32_16x16x32_bf16 v[172:175], v[68:71], v[84:87], v[172:175]
    ds_read_b64_tr_b16 v[54:55], v9 offset:8704
    s_add_u32 s21, s21, 12288
    s_cmp_eq_u32 s21, 61440
    s_cselect_b32 s21, 0, s21
    v_add_u32 v10, s21, v7
    v_xor_b32 v9, 32, v10
    v_xor_b32 v8, 64, v8
    s_add_u32 s24, s24, 1
    v_mfma_f32_16x16x32_bf16 v[128:131], v[56:59], v[88:91], v[128:131]
    v_mfma_f32_16x16x32_bf16 v[132:135], v[60:63], v[88:91], v[132:135]
    v_mfma_f32_16x16x32_bf16 v[176:179], v[64:67], v[88:91], v[176:179]
    v_mfma_f32_16x16x32_bf16 v[180:183], v[68:71], v[88:91], v[180:183]
    v_mfma_f32_16x16x32_bf16 v[136:139], v[56:59], v[92:95], v[136:139]
    v_mfma_f32_16x16x32_bf16 v[140:143], v[60:63], v[92:95], v[140:143]
    v_mfma_f32_16x16x32_bf16 v[184:187], v[64:67], v[92:95], v[184:187]
    v_mfma_f32_16x16x32_bf16 v[188:191], v[68:71], v[92:95], v[188:191]
    s_cmp_lt_u32 s24, 28
    s_cbranch_scc1 k1_loop_1_2
k1_tail_1:
    s_waitcnt vmcnt(8) lgkmcnt(0)
    s_barrier
    v_mfma_f32_16x16x32_bf16 v[96:99], v[32:35], v[16:19], v[96:99]
    ds_read_b128 v[56:59], v8 offset:0
    v_mfma_f32_16x16x32_bf16 v[104:107], v[32:35], v[20:23], v[104:107]
    ds_read_b128 v[60:63], v8 offset:2048
    v_mfma_f32_16x16x32_bf16 v[144:147], v[32:35], v[24:27], v[144:147]
    ds_read_b128 v[64:67], v8 offset:4096
    v_mfma_f32_16x16x32_bf16 v[152:155], v[32:35], v[28:31], v[152:155]
    ds_read_b128 v[68:71], v8 offset:6144
    v_mfma_f32_16x16x32_bf16 v[100:103], v[36:39], v[16:19], v[100:103]
    ds_read_b64_tr_b16 v[72:73], v10 offset:0
    v_mfma_f32_16x16x32_bf16 v[108:111], v[36:39], v[20:23], v[108:111]
    ds_read_b64_tr_b16 v[74:75], v10 offset:512
    v_mfma_f32_16x16x32_bf16 v[148:151], v[36:39], v[24:27], v[148:151]
    ds_read_b64_tr_b16 v[76:77], v9 offset:0
    v_mfma_f32_16x16x32_bf16 v[156:159], v[36:39], v[28:31], v[156:159]
    ds_read_b64_tr_b16 v[78:79], v9 offset:512
    v_mfma_f32_16x16x32_bf16 v[112:115], v[16:19], v[40:43], v[112:115]
    ds_read_b64_tr_b16 v[80:81], v10 offset:4096
    v_mfma_f32_16x16x32_bf16 v[116:119], v[20:23], v[40:43], v[116:119]
    ds_read_b64_tr_b16 v[82:83], v10 offset:4608
    v_mfma_f32_16x16x32_bf16 v[160:163], v[24:27], v[40:43], v[160:163]
    ds_read_b64_tr_b16 v[84:85], v9 offset:4096
    v_mfma_f32_16x16x32_bf16 v[164:167], v[28:31], v[40:43], v[164:167]
    ds_read_b64_tr_b16 v[86:87], v9 offset:4608
    v_mfma_f32_16x16x32_bf16 v[120:123], v[16:19], v[44:47], v[120:123]
    ds_read_b64_tr_b16 v[88:89], v10 offset:8192
    v_mfma_f32_16x16x32_bf16 v[124:127], v[20:23], v[44:47], v[124:127]
    ds_read_b64_tr_b16 v[90:91], v10 offset:8704
    v_mfma_f32_16x16x32_bf16 v[168:171], v[24:27], v[44:47], v[168:171]
    ds_read_b64_tr_b16 v[92:93], v9 offset:8192
    v_mfma_f32_16x16x32_bf16 v[172:175], v[28:31], v[44:47], v[172:175]
    ds_read_b64_tr_b16 v[94:95], v9 offset:8704
    s_add_u32 s21, s21, 12288
    s_cmp_eq_u32 s21, 61440
    s_cselect_b32 s21, 0, s21
    v_add_u32 v10, s21, v7
    v_xor_b32 v9, 32, v10
    s_add_u32 s16, s16, 32768
    s_cmp_eq_u32 s16, 98304
    s_cselect_b32 s16, 0, s16
    v_add_u32 v8, s16, v5
    v_mfma_f32_16x16x32_bf16 v[128:131], v[16:19], v[48:51], v[128:131]
    v_mfma_f32_16x16x32_bf16 v[132:135], v[20:23], v[48:51], v[132:135]
    v_mfma_f32_16x16x32_bf16 v[176:179], v[24:27], v[48:51], v[176:179]
    v_mfma_f32_16x16x32_bf16 v[180:183], v[28:31], v[48:51], v[180:183]
    v_mfma_f32_16x16x32_bf16 v[136:139], v[16:19], v[52:55], v[136:139]
    v_mfma_f32_16x16x32_bf16 v[140:143], v[20:23], v[52:55], v[140:143]
    v_mfma_f32_16x16x32_bf16 v[184:187], v[24:27], v[52:55], v[184:187]
    v_mfma_f32_16x16x32_bf16 v[188:191], v[28:31], v[52:55], v[188:191]
    s_cmp_eq_u32 s29, 7
    s_cbranch_scc1 k1_tail_a1
    s_waitcnt vmcnt(0)
k1_tail_a1:
    s_cmp_lt_u32 s29, 4
    s_cbranch_scc0 k1_tail_b1
    s_setprio 3
k1_tail_b1:
    s_waitcnt lgkmcnt(0)
    s_barrier
    v_mfma_f32_16x16x32_bf16 v[96:99], v[72:75], v[56:59], v[96:99]
    ds_read_b128 v[16:19], v8 offset:0
    v_mfma_f32_16x16x32_bf16 v[104:107], v[72:75], v[60:63], v[104:107]
    ds_read_b128 v[20:23], v8 offset:2048
    v_mfma_f32_16x16x32_bf16 v[144:147], v[72:75], v[64:67], v[144:147]
    ds_read_b128 v[24:27], v8 offset:4096
    v_mfma_f32_16x16x32_bf16 v[152:155], v[72:75], v[68:71], v[152:155]
    ds_read_b128 v[28:31], v8 offset:6144
    v_mfma_f32_16x16x32_bf16 v[100:103], v[76:79], v[56:59], v[100:103]
    ds_read_b64_tr_b16 v[32:33], v10 offset:0
    v_mfma_f32_16x16x32_bf16 v[108:111], v[76:79], v[60:63], v[108:111]
    ds_read_b64_tr_b16 v[34:35], v10 offset:512
    v_mfma_f32_16x16x32_bf16 v[148:151], v[76:79], v[64:67], v[148:151]
    ds_read_b64_tr_b16 v[36:37], v9 offset:0
    v_mfma_f32_16x16x32_bf16 v[156:159], v[76:79], v[68:71], v[156:159]
    ds_read_b64_tr_b16 v[38:39], v9 offset:512
    v_mfma_f32_16x16x32_bf16 v[112:115], v[56:59], v[80:83], v[112:115]
    ds_read_b64_tr_b16 v[40:41], v10 offset:4096
    v_mfma_f32_16x16x32_bf16 v[116:119], v[60:63], v[80:83], v[116:119]
    ds_read_b64_tr_b16 v[42:43], v10 offset:4608
    v_mfma_f32_16x16x32_bf16 v[160:163], v[64:67], v[80:83], v[160:163]
    ds_read_b64_tr_b16 v[44:45], v9 offset:4096
    v_mfma_f32_16x16x32_bf16 v[164:167], v[68:71], v[80:83], v[164:167]
    ds_read_b64_tr_b16 v[46:47], v9 offset:4608
    v_mfma_f32_16x16x32_bf16 v[120:123], v[56:59], v[84:87], v[120:123]
    ds_read_b64_tr_b16 v[48:49], v10 offset:8192
    v_mfma_f32_16x16x32_bf16 v[124:127], v[60:63], v[84:87], v[124:127]
    ds_read_b64_tr_b16 v[50:51], v10 offset:8704
    v_mfma_f32_16x16x32_bf16 v[168:171], v[64:67], v[84:87], v[168:171]
    ds_read_b64_tr_b16 v[52:53], v9 offset:8192
    v_mfma_f32_16x16x32_bf16 v[172:175], v[68:71], v[84:87], v[172:175]
    ds_read_b64_tr_b16 v[54:55], v9 offset:8704
    s_add_u32 s21, s21, 12288
    s_cmp_eq_u32 s21, 61440
    s_cselect_b32 s21, 0, s21
    v_add_u32 v10, s21, v7
    v_xor_b32 v9, 32, v10
    v_xor_b32 v8, 64, v8
    v_mfma_f32_16x16x32_bf16 v[128:131], v[56:59], v[88:91], v[128:131]
    v_mfma_f32_16x16x32_bf16 v[132:135], v[60:63], v[88:91], v[132:135]
    v_mfma_f32_16x16x32_bf16 v[176:179], v[64:67], v[88:91], v[176:179]
    v_mfma_f32_16x16x32_bf16 v[180:183], v[68:71], v[88:91], v[180:183]
    v_mfma_f32_16x16x32_bf16 v[136:139], v[56:59], v[92:95], v[136:139]
    v_mfma_f32_16x16x32_bf16 v[140:143], v[60:63], v[92:95], v[140:143]
    v_mfma_f32_16x16x32_bf16 v[184:187], v[64:67], v[92:95], v[184:187]
    v_mfma_f32_16x16x32_bf16 v[188:191], v[68:71], v[92:95], v[188:191]
    s_waitcnt lgkmcnt(0)
    v_mfma_f32_16x16x32_bf16 v[96:99], v[32:35], v[16:19], v[96:99]
    ds_read_b128 v[56:59], v8 offset:0
    v_mfma_f32_16x16x32_bf16 v[104:107], v[32:35], v[20:23], v[104:107]
    ds_read_b128 v[60:63], v8 offset:2048
    v_mfma_f32_16x16x32_bf16 v[144:147], v[32:35], v[24:27], v[144:147]
    ds_read_b128 v[64:67], v8 offset:4096
    v_mfma_f32_16x16x32_bf16 v[152:155], v[32:35], v[28:31], v[152:155]
    ds_read_b128 v[68:71], v8 offset:6144
    v_mfma_f32_16x16x32_bf16 v[100:103], v[36:39], v[16:19], v[100:103]
    ds_read_b64_tr_b16 v[72:73], v10 offset:0
    v_mfma_f32_16x16x32_bf16 v[108:111], v[36:39], v[20:23], v[108:111]
    ds_read_b64_tr_b16 v[74:75], v10 offset:512
    v_mfma_f32_16x16x32_bf16 v[148:151], v[36:39], v[24:27], v[148:151]
    ds_read_b64_tr_b16 v[76:77], v9 offset:0
    v_mfma_f32_16x16x32_bf16 v[156:159], v[36:39], v[28:31], v[156:159]
    ds_read_b64_tr_b16 v[78:79], v9 offset:512
    v_mfma_f32_16x16x32_bf16 v[112:115], v[16:19], v[40:43], v[112:115]
    ds_read_b64_tr_b16 v[80:81], v10 offset:4096
    v_mfma_f32_16x16x32_bf16 v[116:119], v[20:23], v[40:43], v[116:119]
    ds_read_b64_tr_b16 v[82:83], v10 offset:4608
    v_mfma_f32_16x16x32_bf16 v[160:163], v[24:27], v[40:43], v[160:163]
    ds_read_b64_tr_b16 v[84:85], v9 offset:4096
    v_mfma_f32_16x16x32_bf16 v[164:167], v[28:31], v[40:43], v[164:167]
    ds_read_b64_tr_b16 v[86:87], v9 offset:4608
    v_mfma_f32_16x16x32_bf16 v[120:123], v[16:19], v[44:47], v[120:123]
    ds_read_b64_tr_b16 v[88:89], v10 offset:8192
    v_mfma_f32_16x16x32_bf16 v[124:127], v[20:23], v[44:47], v[124:127]
    ds_read_b64_tr_b16 v[90:91], v10 offset:8704
    v_mfma_f32_16x16x32_bf16 v[168:171], v[24:27], v[44:47], v[168:171]
    ds_read_b64_tr_b16 v[92:93], v9 offset:8192
    v_mfma_f32_16x16x32_bf16 v[172:175], v[28:31], v[44:47], v[172:175]
    ds_read_b64_tr_b16 v[94:95], v9 offset:8704
    s_add_u32 s21, s21, 12288
    s_cmp_eq_u32 s21, 61440
    s_cselect_b32 s21, 0, s21
    v_add_u32 v10, s21, v7
    v_xor_b32 v9, 32, v10
    s_add_u32 s16, s16, 32768
    s_cmp_eq_u32 s16, 98304
    s_cselect_b32 s16, 0, s16
    v_add_u32 v8, s16, v5
    v_mfma_f32_16x16x32_bf16 v[128:131], v[16:19], v[48:51], v[128:131]
    v_mfma_f32_16x16x32_bf16 v[132:135], v[20:23], v[48:51], v[132:135]
    v_mfma_f32_16x16x32_bf16 v[176:179], v[24:27], v[48:51], v[176:179]
    v_mfma_f32_16x16x32_bf16 v[180:183], v[28:31], v[48:51], v[180:183]
    v_mfma_f32_16x16x32_bf16 v[136:139], v[16:19], v[52:55], v[136:139]
    v_mfma_f32_16x16x32_bf16 v[140:143], v[20:23], v[52:55], v[140:143]
    v_mfma_f32_16x16x32_bf16 v[184:187], v[24:27], v[52:55], v[184:187]
    v_mfma_f32_16x16x32_bf16 v[188:191], v[28:31], v[52:55], v[188:191]
    s_waitcnt lgkmcnt(0)
    v_mfma_f32_16x16x32_bf16 v[96:99], v[72:75], v[56:59], v[96:99]
    v_mfma_f32_16x16x32_bf16 v[104:107], v[72:75], v[60:63], v[104:107]
    v_mfma_f32_16x16x32_bf16 v[144:147], v[72:75], v[64:67], v[144:147]
    v_mfma_f32_16x16x32_bf16 v[152:155], v[72:75], v[68:71], v[152:155]
    v_mfma_f32_16x16x32_bf16 v[100:103], v[76:79], v[56:59], v[100:103]
    v_mfma_f32_16x16x32_bf16 v[108:111], v[76:79], v[60:63], v[108:111]
    v_mfma_f32_16x16x32_bf16 v[148:151], v[76:79], v[64:67], v[148:151]
    v_mfma_f32_16x16x32_bf16 v[156:159], v[76:79], v[68:71], v[156:159]
    v_mfma_f32_16x16x32_bf16 v[112:115], v[56:59], v[80:83], v[112:115]
    v_mfma_f32_16x16x32_bf16 v[116:119], v[60:63], v[80:83], v[116:119]
    v_mfma_f32_16x16x32_bf16 v[160:163], v[64:67], v[80:83], v[160:163]
    v_mfma_f32_16x16x32_bf16 v[164:167], v[68:71], v[80:83], v[164:167]
    v_mfma_f32_16x16x32_bf16 v[120:123], v[56:59], v[84:87], v[120:123]
    v_mfma_f32_16x16x32_bf16 v[124:127], v[60:63], v[84:87], v[124:127]
    v_mfma_f32_16x16x32_bf16 v[168:171], v[64:67], v[84:87], v[168:171]
    v_mfma_f32_16x16x32_bf16 v[172:175], v[68:71], v[84:87], v[172:175]
    v_mfma_f32_16x16x32_bf16 v[128:131], v[56:59], v[88:91], v[128:131]
    v_mfma_f32_16x16x32_bf16 v[132:135], v[60:63], v[88:91], v[132:135]
    v_mfma_f32_16x16x32_bf16 v[176:179], v[64:67], v[88:91], v[176:179]
    v_mfma_f32_16x16x32_bf16 v[180:183], v[68:71], v[88:91], v[180:183]
    v_mfma_f32_16x16x32_bf16 v[136:139], v[56:59], v[92:95], v[136:139]
    v_mfma_f32_16x16x32_bf16 v[140:143], v[60:63], v[92:95], v[140:143]
    v_mfma_f32_16x16x32_bf16 v[184:187], v[64:67], v[92:95], v[184:187]
    v_mfma_f32_16x16x32_bf16 v[188:191], v[68:71], v[92:95], v[188:191]
    s_branch k1_epi_1
k1_pfc_1:
    v_add_u32 v2, 8192, v14
    v_min_u32 v2, text_end-qkv_kernel-4, v2
    global_load_dword v15, v2, s[44:45]
    v_add_u32 v2, 16384, v14
    v_min_u32 v2, text_end-qkv_kernel-4, v2
    global_load_dword v15, v2, s[44:45]
    v_lshrrev_b32 v2, 2, v11
    v_mov_b32 v3, 0
    s_lshl_b32 s33, s2, 9
    s_add_u32 s33, s33, 31457280
    buffer_store_dword v3, v2, s[12:15], s33 offen sc1
    buffer_store_dword v3, v2, s[12:15], s33 offen offset:256 sc1
    s_branch k1_pfc_back_1
k1_epi_0:
    s_lshl_b32 s33, s27, 3
    s_lshl_b32 s34, s30, 1
    s_add_u32 s33, s33, s34
    s_lshl_b32 s34, s32, 6
    s_add_u32 s33, s33, s34
    s_lshl_b32 s34, s33, 11
    s_lshl_b32 s35, s33, 12
    s_add_u32 s35, s35, 4194304
    s_add_u32 s36, s35, 4096
    s_mov_b32 s24, 0x3e8293ee
    v_lshrrev_b32 v2, 4, v1
    v_lshlrev_b32 v2, 9, v2
    v_and_b32 v3, 15, v1
    v_lshl_add_u32 v11, v3, 4, v2
    v_and_b32 v3, 12, v1
    v_lshl_add_u32 v2, v3, 4, v11

    v_mul_f32 v96, s24, v96
    v_mul_f32 v97, s24, v97
    v_mul_f32 v98, s24, v98
    v_mul_f32 v99, s24, v99
    v_mul_f32 v100, s24, v100
    v_mul_f32 v101, s24, v101
    v_mul_f32 v102, s24, v102
    v_mul_f32 v103, s24, v103
    v_mul_f32 v104, s24, v104
    v_mul_f32 v105, s24, v105
    v_mul_f32 v106, s24, v106
    v_mul_f32 v107, s24, v107
    v_mul_f32 v108, s24, v108
    v_mul_f32 v109, s24, v109
    v_mul_f32 v110, s24, v110
    v_mul_f32 v111, s24, v111
    v_cvt_pk_bf16_f32 v16, v96, v97
    v_cvt_pk_bf16_f32 v17, v98, v99
    v_cvt_pk_bf16_f32 v18, v100, v101
    v_cvt_pk_bf16_f32 v19, v102, v103
    v_cvt_pk_bf16_f32 v20, v104, v105
    v_cvt_pk_bf16_f32 v21, v106, v107
    v_cvt_pk_bf16_f32 v22, v108, v109
    v_cvt_pk_bf16_f32 v23, v110, v111
    buffer_store_dwordx4 v[16:19], v11, s[12:15], s34 offen offset:0 sc1
    buffer_store_dwordx4 v[20:23], v11, s[12:15], s34 offen offset:256 sc1
    v_cvt_pk_bf16_f32 v24, v112, v113
    v_cvt_pk_bf16_f32 v25, v114, v115
    v_cvt_pk_bf16_f32 v26, v116, v117
    v_cvt_pk_bf16_f32 v27, v118, v119
    v_cvt_pk_bf16_f32 v28, v120, v121
    v_cvt_pk_bf16_f32 v29, v122, v123
    v_cvt_pk_bf16_f32 v30, v124, v125
    v_cvt_pk_bf16_f32 v31, v126, v127
    buffer_store_dwordx4 v[24:27], v11, s[12:15], s35 offen offset:0 sc1
    buffer_store_dwordx4 v[28:31], v11, s[12:15], s35 offen offset:256 sc1
    v_cvt_pk_bf16_f32 v32, v128, v129
    v_cvt_pk_bf16_f32 v33, v130, v131
    v_cvt_pk_bf16_f32 v34, v132, v133
    v_cvt_pk_bf16_f32 v35, v134, v135
    v_cvt_pk_bf16_f32 v36, v136, v137
    v_cvt_pk_bf16_f32 v37, v138, v139
    v_cvt_pk_bf16_f32 v38, v140, v141
    v_cvt_pk_bf16_f32 v39, v142, v143
    buffer_store_dwordx4 v[32:35], v11, s[12:15], s35 offen offset:2048 sc1
    buffer_store_dwordx4 v[36:39], v11, s[12:15], s35 offen offset:2304 sc1
    v_mul_f32 v144, s24, v144
    v_mul_f32 v145, s24, v145
    v_mul_f32 v146, s24, v146
    v_mul_f32 v147, s24, v147
    v_mul_f32 v148, s24, v148
    v_mul_f32 v149, s24, v149
    v_mul_f32 v150, s24, v150
    v_mul_f32 v151, s24, v151
    v_mul_f32 v152, s24, v152
    v_mul_f32 v153, s24, v153
    v_mul_f32 v154, s24, v154
    v_mul_f32 v155, s24, v155
    v_mul_f32 v156, s24, v156
    v_mul_f32 v157, s24, v157
    v_mul_f32 v158, s24, v158
    v_mul_f32 v159, s24, v159
    v_cvt_pk_bf16_f32 v40, v144, v145
    v_cvt_pk_bf16_f32 v41, v146, v147
    v_cvt_pk_bf16_f32 v42, v148, v149
    v_cvt_pk_bf16_f32 v43, v150, v151
    v_cvt_pk_bf16_f32 v44, v152, v153
    v_cvt_pk_bf16_f32 v45, v154, v155
    v_cvt_pk_bf16_f32 v46, v156, v157
    v_cvt_pk_bf16_f32 v47, v158, v159
    buffer_store_dwordx4 v[40:43], v11, s[12:15], s34 offen offset:2048 sc1
    buffer_store_dwordx4 v[44:47], v11, s[12:15], s34 offen offset:2304 sc1
    v_cvt_pk_bf16_f32 v48, v160, v161
    v_cvt_pk_bf16_f32 v49, v162, v163
    v_cvt_pk_bf16_f32 v50, v164, v165
    v_cvt_pk_bf16_f32 v51, v166, v167
    v_cvt_pk_bf16_f32 v52, v168, v169
    v_cvt_pk_bf16_f32 v53, v170, v171
    v_cvt_pk_bf16_f32 v54, v172, v173
    v_cvt_pk_bf16_f32 v55, v174, v175
    buffer_store_dwordx4 v[48:51], v11, s[12:15], s36 offen offset:0 sc1
    buffer_store_dwordx4 v[52:55], v11, s[12:15], s36 offen offset:256 sc1
    v_cvt_pk_bf16_f32 v56, v176, v177
    v_cvt_pk_bf16_f32 v57, v178, v179
    v_cvt_pk_bf16_f32 v58, v180, v181
    v_cvt_pk_bf16_f32 v59, v182, v183
    v_cvt_pk_bf16_f32 v60, v184, v185
    v_cvt_pk_bf16_f32 v61, v186, v187
    v_cvt_pk_bf16_f32 v62, v188, v189
    v_cvt_pk_bf16_f32 v63, v190, v191
    buffer_store_dwordx4 v[56:59], v11, s[12:15], s36 offen offset:2048 sc1
    buffer_store_dwordx4 v[60:63], v11, s[12:15], s36 offen offset:2304 sc1
    s_branch k1_end
k1_epi_1:
    s_lshl_b32 s33, s27, 3
    s_lshl_b32 s34, s30, 1
    s_add_u32 s33, s33, s34
    s_lshl_b32 s34, s32, 6
    s_add_u32 s33, s33, s34
    s_lshl_b32 s36, s33, 11
    s_add_u32 s36, s36, 12582912
    s_mov_b32 s24, 0x3fb8aa3b
    s_mov_b32 s35, 0x358637bd
    v_lshrrev_b32 v2, 4, v1
    v_lshlrev_b32 v2, 9, v2
    v_and_b32 v3, 15, v1
    v_lshl_add_u32 v4, v3, 4, v2
    v_and_b32 v2, 32, v1
    v_lshl_add_u32 v6, v2, 5, v4
    s_waitcnt vmcnt(0)

    v_cvt_pk_bf16_f32 v32, v128, v129
    v_cvt_pk_bf16_f32 v33, v130, v131
    v_cvt_pk_bf16_f32 v34, v132, v133
    v_cvt_pk_bf16_f32 v35, v134, v135
    v_cvt_pk_bf16_f32 v36, v136, v137
    v_cvt_pk_bf16_f32 v37, v138, v139
    v_cvt_pk_bf16_f32 v38, v140, v141
    v_cvt_pk_bf16_f32 v39, v142, v143
    v_cvt_pk_bf16_f32 v40, v176, v177
    v_cvt_pk_bf16_f32 v41, v178, v179
    v_cvt_pk_bf16_f32 v42, v180, v181
    v_cvt_pk_bf16_f32 v43, v182, v183
    v_cvt_pk_bf16_f32 v44, v184, v185
    v_cvt_pk_bf16_f32 v45, v186, v187
    v_cvt_pk_bf16_f32 v46, v188, v189
    v_cvt_pk_bf16_f32 v47, v190, v191
    v_mov_b32 v64, 0x3f803f80
    v_mov_b32 v65, 0x3f803f80
    v_mov_b32 v66, 0x3f803f80
    v_mov_b32 v67, 0x3f803f80
    v_pk_mul_f32 v[128:129], v[112:113], s[24:25] op_sel_hi:[1,0]
    v_pk_mul_f32 v[130:131], v[114:115], s[24:25] op_sel_hi:[1,0]
    v_pk_mul_f32 v[132:133], v[116:117], s[24:25] op_sel_hi:[1,0]
    v_pk_mul_f32 v[134:135], v[118:119], s[24:25] op_sel_hi:[1,0]
    v_pk_mul_f32 v[136:137], v[120:121], s[24:25] op_sel_hi:[1,0]
    v_pk_mul_f32 v[138:139], v[122:123], s[24:25] op_sel_hi:[1,0]
    v_pk_mul_f32 v[140:141], v[124:125], s[24:25] op_sel_hi:[1,0]
    v_pk_mul_f32 v[142:143], v[126:127], s[24:25] op_sel_hi:[1,0]
    v_exp_f32_e64 v128, v128 clamp
    v_max_f32 v112, s35, v112
    v_exp_f32_e64 v129, v129 clamp
    v_max_f32 v113, s35, v113
    v_exp_f32_e64 v130, v130 clamp
    v_max_f32 v114, s35, v114
    v_exp_f32_e64 v131, v131 clamp
    v_max_f32 v115, s35, v115
    v_exp_f32_e64 v132, v132 clamp
    v_max_f32 v116, s35, v116
    v_exp_f32_e64 v133, v133 clamp
    v_max_f32 v117, s35, v117
    v_exp_f32_e64 v134, v134 clamp
    v_max_f32 v118, s35, v118
    v_exp_f32_e64 v135, v135 clamp
    v_max_f32 v119, s35, v119
    v_exp_f32_e64 v136, v136 clamp
    v_max_f32 v120, s35, v120
    v_exp_f32_e64 v137, v137 clamp
    v_max_f32 v121, s35, v121
    v_exp_f32_e64 v138, v138 clamp
    v_max_f32 v122, s35, v122
    v_exp_f32_e64 v139, v139 clamp
    v_max_f32 v123, s35, v123
    v_exp_f32_e64 v140, v140 clamp
    v_max_f32 v124, s35, v124
    v_exp_f32_e64 v141, v141 clamp
    v_max_f32 v125, s35, v125
    v_exp_f32_e64 v142, v142 clamp
    v_max_f32 v126, s35, v126
    v_exp_f32_e64 v143, v143 clamp
    v_max_f32 v127, s35, v127
    v_pk_add_f32 v[112:113], v[112:113], v[128:129]
    v_pk_add_f32 v[114:115], v[114:115], v[130:131]
    v_pk_add_f32 v[116:117], v[116:117], v[132:133]
    v_pk_add_f32 v[118:119], v[118:119], v[134:135]
    v_pk_add_f32 v[120:121], v[120:121], v[136:137]
    v_pk_add_f32 v[122:123], v[122:123], v[138:139]
    v_pk_add_f32 v[124:125], v[124:125], v[140:141]
    v_pk_add_f32 v[126:127], v[126:127], v[142:143]
    v_cvt_pk_bf16_f32 v48, v112, v113
    v_cvt_pk_bf16_f32 v49, v114, v115
    v_cvt_pk_bf16_f32 v50, v116, v117
    v_cvt_pk_bf16_f32 v51, v118, v119
    v_cvt_pk_bf16_f32 v52, v120, v121
    v_cvt_pk_bf16_f32 v53, v122, v123
    v_cvt_pk_bf16_f32 v54, v124, v125
    v_cvt_pk_bf16_f32 v55, v126, v127
    v_pk_mul_f32 v[176:177], v[160:161], s[24:25] op_sel_hi:[1,0]
    v_pk_mul_f32 v[178:179], v[162:163], s[24:25] op_sel_hi:[1,0]
    v_pk_mul_f32 v[180:181], v[164:165], s[24:25] op_sel_hi:[1,0]
    v_pk_mul_f32 v[182:183], v[166:167], s[24:25] op_sel_hi:[1,0]
    v_pk_mul_f32 v[184:185], v[168:169], s[24:25] op_sel_hi:[1,0]
    v_pk_mul_f32 v[186:187], v[170:171], s[24:25] op_sel_hi:[1,0]
    v_pk_mul_f32 v[188:189], v[172:173], s[24:25] op_sel_hi:[1,0]
    v_pk_mul_f32 v[190:191], v[174:175], s[24:25] op_sel_hi:[1,0]
    v_exp_f32_e64 v176, v176 clamp
    v_max_f32 v160, s35, v160
    v_exp_f32_e64 v177, v177 clamp
    v_max_f32 v161, s35, v161
    v_exp_f32_e64 v178, v178 clamp
    v_max_f32 v162, s35, v162
    v_exp_f32_e64 v179, v179 clamp
    v_max_f32 v163, s35, v163
    v_exp_f32_e64 v180, v180 clamp
    v_max_f32 v164, s35, v164
    v_exp_f32_e64 v181, v181 clamp
    v_max_f32 v165, s35, v165
    v_exp_f32_e64 v182, v182 clamp
    v_max_f32 v166, s35, v166
    v_exp_f32_e64 v183, v183 clamp
    v_max_f32 v167, s35, v167
    v_exp_f32_e64 v184, v184 clamp
    v_max_f32 v168, s35, v168
    v_exp_f32_e64 v185, v185 clamp
    v_max_f32 v169, s35, v169
    v_exp_f32_e64 v186, v186 clamp
    v_max_f32 v170, s35, v170
    v_exp_f32_e64 v187, v187 clamp
    v_max_f32 v171, s35, v171
    v_exp_f32_e64 v188, v188 clamp
    v_max_f32 v172, s35, v172
    v_exp_f32_e64 v189, v189 clamp
    v_max_f32 v173, s35, v173
    v_exp_f32_e64 v190, v190 clamp
    v_max_f32 v174, s35, v174
    v_exp_f32_e64 v191, v191 clamp
    v_max_f32 v175, s35, v175
    v_pk_add_f32 v[160:161], v[160:161], v[176:177]
    v_pk_add_f32 v[162:163], v[162:163], v[178:179]
    v_pk_add_f32 v[164:165], v[164:165], v[180:181]
    v_pk_add_f32 v[166:167], v[166:167], v[182:183]
    v_pk_add_f32 v[168:169], v[168:169], v[184:185]
    v_pk_add_f32 v[170:171], v[170:171], v[186:187]
    v_pk_add_f32 v[172:173], v[172:173], v[188:189]
    v_pk_add_f32 v[174:175], v[174:175], v[190:191]
    v_cvt_pk_bf16_f32 v56, v160, v161
    v_cvt_pk_bf16_f32 v57, v162, v163
    v_cvt_pk_bf16_f32 v58, v164, v165
    v_cvt_pk_bf16_f32 v59, v166, v167
    v_cvt_pk_bf16_f32 v60, v168, v169
    v_cvt_pk_bf16_f32 v61, v170, v171
    v_cvt_pk_bf16_f32 v62, v172, v173
    v_cvt_pk_bf16_f32 v63, v174, v175
    s_nop 1
    v_mfma_f32_16x16x32_bf16 v[112:115], v[48:51], v[32:35], 0
    v_mfma_f32_16x16x32_bf16 v[116:119], v[48:51], v[36:39], 0
    v_mfma_f32_16x16x32_bf16 v[160:163], v[48:51], v[64:67], 0
    v_mfma_f32_16x16x32_bf16 v[120:123], v[52:55], v[32:35], 0
    v_mfma_f32_16x16x32_bf16 v[124:127], v[52:55], v[36:39], 0
    v_mfma_f32_16x16x32_bf16 v[164:167], v[52:55], v[64:67], 0
    v_mfma_f32_16x16x32_bf16 v[112:115], v[56:59], v[40:43], v[112:115]
    v_mfma_f32_16x16x32_bf16 v[116:119], v[56:59], v[44:47], v[116:119]
    v_mfma_f32_16x16x32_bf16 v[160:163], v[56:59], v[64:67], v[160:163]
    v_mfma_f32_16x16x32_bf16 v[120:123], v[60:63], v[40:43], v[120:123]
    v_mfma_f32_16x16x32_bf16 v[124:127], v[60:63], v[44:47], v[124:127]
    v_mfma_f32_16x16x32_bf16 v[164:167], v[60:63], v[64:67], v[164:167]
    s_barrier
    s_lshl_b32 s33, s29, 13
    v_add_u32 v2, s33, v6
    s_nop 4

    ds_write_b128 v2, v[112:115] offset:0
    ds_write_b128 v2, v[116:119] offset:256
    ds_write_b128 v2, v[120:123] offset:1024
    ds_write_b128 v2, v[124:127] offset:1280
    ds_write_b128 v2, v[160:163] offset:4096
    ds_write_b128 v2, v[160:163] offset:4352
    ds_write_b128 v2, v[164:167] offset:5120
    ds_write_b128 v2, v[164:167] offset:5376
    s_lshl_b32 s33, s31, 15
    s_lshl_b32 s34, s30, 11
    s_add_u32 s33, s33, s34
    v_add_u32 v2, s33, v11

    v_pk_mul_f32 v[128:129], v[96:97], s[24:25] op_sel_hi:[1,0]
    v_pk_mul_f32 v[130:131], v[98:99], s[24:25] op_sel_hi:[1,0]
    v_pk_mul_f32 v[132:133], v[100:101], s[24:25] op_sel_hi:[1,0]
    v_pk_mul_f32 v[134:135], v[102:103], s[24:25] op_sel_hi:[1,0]
    v_pk_mul_f32 v[136:137], v[104:105], s[24:25] op_sel_hi:[1,0]
    v_pk_mul_f32 v[138:139], v[106:107], s[24:25] op_sel_hi:[1,0]
    v_pk_mul_f32 v[140:141], v[108:109], s[24:25] op_sel_hi:[1,0]
    v_pk_mul_f32 v[142:143], v[110:111], s[24:25] op_sel_hi:[1,0]
    v_exp_f32_e64 v128, v128 clamp
    v_max_f32 v96, s35, v96
    v_exp_f32_e64 v129, v129 clamp
    v_max_f32 v97, s35, v97
    v_exp_f32_e64 v130, v130 clamp
    v_max_f32 v98, s35, v98
    v_exp_f32_e64 v131, v131 clamp
    v_max_f32 v99, s35, v99
    v_exp_f32_e64 v132, v132 clamp
    v_max_f32 v100, s35, v100
    v_exp_f32_e64 v133, v133 clamp
    v_max_f32 v101, s35, v101
    v_exp_f32_e64 v134, v134 clamp
    v_max_f32 v102, s35, v102
    v_exp_f32_e64 v135, v135 clamp
    v_max_f32 v103, s35, v103
    v_exp_f32_e64 v136, v136 clamp
    v_max_f32 v104, s35, v104
    v_exp_f32_e64 v137, v137 clamp
    v_max_f32 v105, s35, v105
    v_exp_f32_e64 v138, v138 clamp
    v_max_f32 v106, s35, v106
    v_exp_f32_e64 v139, v139 clamp
    v_max_f32 v107, s35, v107
    v_exp_f32_e64 v140, v140 clamp
    v_max_f32 v108, s35, v108
    v_exp_f32_e64 v141, v141 clamp
    v_max_f32 v109, s35, v109
    v_exp_f32_e64 v142, v142 clamp
    v_max_f32 v110, s35, v110
    v_exp_f32_e64 v143, v143 clamp
    v_max_f32 v111, s35, v111
    v_pk_add_f32 v[96:97], v[96:97], v[128:129]
    v_pk_add_f32 v[98:99], v[98:99], v[130:131]
    v_pk_add_f32 v[100:101], v[100:101], v[132:133]
    v_pk_add_f32 v[102:103], v[102:103], v[134:135]
    v_pk_add_f32 v[104:105], v[104:105], v[136:137]
    v_pk_add_f32 v[106:107], v[106:107], v[138:139]
    v_pk_add_f32 v[108:109], v[108:109], v[140:141]
    v_pk_add_f32 v[110:111], v[110:111], v[142:143]
    v_cvt_pk_bf16_f32 v68, v96, v97
    v_cvt_pk_bf16_f32 v69, v98, v99
    v_cvt_pk_bf16_f32 v70, v100, v101
    v_cvt_pk_bf16_f32 v71, v102, v103
    v_cvt_pk_bf16_f32 v72, v104, v105
    v_cvt_pk_bf16_f32 v73, v106, v107
    v_cvt_pk_bf16_f32 v74, v108, v109
    v_cvt_pk_bf16_f32 v75, v110, v111
    buffer_store_dwordx4 v[68:71], v4, s[12:15], s36 offen offset:0 sc1
    buffer_store_dwordx4 v[72:75], v4, s[12:15], s36 offen offset:256 sc1
    s_waitcnt lgkmcnt(0)
    s_barrier

    ds_read_b128 v[16:19], v2 offset:0
    ds_read_b128 v[20:23], v2 offset:1024
    ds_read_b128 v[24:27], v2 offset:8192
    ds_read_b128 v[28:31], v2 offset:9216
    ds_read_b128 v[32:35], v2 offset:16384
    ds_read_b128 v[36:39], v2 offset:17408
    ds_read_b128 v[40:43], v2 offset:24576
    ds_read_b128 v[44:47], v2 offset:25600
    s_lshl_b32 s33, s32, 3
    s_add_u32 s33, s33, s27
    s_lshl_b32 s33, s33, 13
    s_add_u32 s33, s33, s34
    s_add_u32 s33, s33, 16777216

    v_pk_mul_f32 v[176:177], v[144:145], s[24:25] op_sel_hi:[1,0]
    v_pk_mul_f32 v[178:179], v[146:147], s[24:25] op_sel_hi:[1,0]
    v_pk_mul_f32 v[180:181], v[148:149], s[24:25] op_sel_hi:[1,0]
    v_pk_mul_f32 v[182:183], v[150:151], s[24:25] op_sel_hi:[1,0]
    v_pk_mul_f32 v[184:185], v[152:153], s[24:25] op_sel_hi:[1,0]
    v_pk_mul_f32 v[186:187], v[154:155], s[24:25] op_sel_hi:[1,0]
    v_pk_mul_f32 v[188:189], v[156:157], s[24:25] op_sel_hi:[1,0]
    v_pk_mul_f32 v[190:191], v[158:159], s[24:25] op_sel_hi:[1,0]
    v_exp_f32_e64 v176, v176 clamp
    v_max_f32 v144, s35, v144
    v_exp_f32_e64 v177, v177 clamp
    v_max_f32 v145, s35, v145
    v_exp_f32_e64 v178, v178 clamp
    v_max_f32 v146, s35, v146
    v_exp_f32_e64 v179, v179 clamp
    v_max_f32 v147, s35, v147
    v_exp_f32_e64 v180, v180 clamp
    v_max_f32 v148, s35, v148
    v_exp_f32_e64 v181, v181 clamp
    v_max_f32 v149, s35, v149
    v_exp_f32_e64 v182, v182 clamp
    v_max_f32 v150, s35, v150
    v_exp_f32_e64 v183, v183 clamp
    v_max_f32 v151, s35, v151
    v_exp_f32_e64 v184, v184 clamp
    v_max_f32 v152, s35, v152
    v_exp_f32_e64 v185, v185 clamp
    v_max_f32 v153, s35, v153
    v_exp_f32_e64 v186, v186 clamp
    v_max_f32 v154, s35, v154
    v_exp_f32_e64 v187, v187 clamp
    v_max_f32 v155, s35, v155
    v_exp_f32_e64 v188, v188 clamp
    v_max_f32 v156, s35, v156
    v_exp_f32_e64 v189, v189 clamp
    v_max_f32 v157, s35, v157
    v_exp_f32_e64 v190, v190 clamp
    v_max_f32 v158, s35, v158
    v_exp_f32_e64 v191, v191 clamp
    v_max_f32 v159, s35, v159
    v_pk_add_f32 v[144:145], v[144:145], v[176:177]
    v_pk_add_f32 v[146:147], v[146:147], v[178:179]
    v_pk_add_f32 v[148:149], v[148:149], v[180:181]
    v_pk_add_f32 v[150:151], v[150:151], v[182:183]
    v_pk_add_f32 v[152:153], v[152:153], v[184:185]
    v_pk_add_f32 v[154:155], v[154:155], v[186:187]
    v_pk_add_f32 v[156:157], v[156:157], v[188:189]
    v_pk_add_f32 v[158:159], v[158:159], v[190:191]
    v_cvt_pk_bf16_f32 v76, v144, v145
    v_cvt_pk_bf16_f32 v77, v146, v147
    v_cvt_pk_bf16_f32 v78, v148, v149
    v_cvt_pk_bf16_f32 v79, v150, v151
    v_cvt_pk_bf16_f32 v80, v152, v153
    v_cvt_pk_bf16_f32 v81, v154, v155
    v_cvt_pk_bf16_f32 v82, v156, v157
    v_cvt_pk_bf16_f32 v83, v158, v159
    buffer_store_dwordx4 v[76:79], v4, s[12:15], s36 offen offset:2048 sc1
    buffer_store_dwordx4 v[80:83], v4, s[12:15], s36 offen offset:2304 sc1
    s_waitcnt lgkmcnt(0)
    v_pk_add_f32 v[16:17], v[16:17], v[24:25]
    v_pk_add_f32 v[32:33], v[32:33], v[40:41]
    v_pk_add_f32 v[18:19], v[18:19], v[26:27]
    v_pk_add_f32 v[34:35], v[34:35], v[42:43]
    v_pk_add_f32 v[20:21], v[20:21], v[28:29]
    v_pk_add_f32 v[36:37], v[36:37], v[44:45]
    v_pk_add_f32 v[22:23], v[22:23], v[30:31]
    v_pk_add_f32 v[38:39], v[38:39], v[46:47]
    v_pk_add_f32 v[16:17], v[16:17], v[32:33]
    v_pk_add_f32 v[18:19], v[18:19], v[34:35]
    v_pk_add_f32 v[20:21], v[20:21], v[36:37]
    v_pk_add_f32 v[22:23], v[22:23], v[38:39]
    s_cmp_lt_u32 s30, 2
    s_cselect_b32 exec_lo, -1, 1
    s_cselect_b32 exec_hi, -1, 1

    buffer_store_dwordx4 v[16:19], v11, s[12:15], s33 offen offset:0 sc1
    buffer_store_dwordx4 v[20:23], v11, s[12:15], s33 offen offset:1024 sc1
k1_end:
    s_endpgm
.globl attn_kernel
.p2align 8
.type attn_kernel,@function
attn_kernel:
    s_cmp_ge_u32 s2, 256
    s_cbranch_scc1 k2_end

    s_load_dwordx2 s[12:13], s[0:1], 64
    s_load_dwordx2 s[8:9], s[0:1], 16
    s_load_dwordx2 s[36:37], s[0:1], 40
    s_load_dwordx2 s[88:89], s[0:1], 48

    v_and_b32 v1, 63, v0
    v_lshrrev_b32 v3, 6, v0
    s_and_b32 s27, s2, 7
    s_lshr_b32 s28, s2, 3
    v_readfirstlane_b32 s18, v3
    s_lshl_b32 s16, s27, 2
    s_lshr_b32 s29, s28, 3
    s_add_u32 s16, s16, s29
    s_and_b32 s17, s28, 7
    s_lshl_b32 s19, s17, 3
    s_add_u32 s19, s19, s18
    s_mov_b32 s14, 268435456
    s_mov_b32 s15, 0x00020000
    s_mov_b32 s26, 268435456
    s_mov_b32 s6, 268435456
    s_mov_b32 s7, 0x00020000
    v_lshlrev_b32 v2, 4, v1
    s_lshl_b32 s27, s16, 6
    s_add_u32 s27, s27, s19
    s_lshl_b32 s27, s27, 11
    s_add_u32 s40, s27, 12582912
    s_lshl_b32 s20, s16, 18
    s_lshl_b32 s25, s18, 12
    s_add_u32 s20, s20, s25
    s_add_u32 s20, s20, 4194304
    s_mov_b32 m0, s25
    v_and_b32 v214, 0x23, v1
    v_lshlrev_b32 v214, 4, v214
    v_bfe_u32 v4, v1, 2, 1
    v_lshl_add_u32 v214, v4, 8, v214
    v_bfe_u32 v4, v1, 3, 2
    v_lshl_add_u32 v214, v4, 6, v214
    s_waitcnt lgkmcnt(0)

    s_mov_b32 s4, s12
    s_mov_b32 s5, s13

    buffer_load_dwordx4 v214, s[4:7], s20 offen offset:0 lds
    buffer_load_dwordx4 v214, s[4:7], s20 offen offset:1024 lds
    buffer_load_dwordx4 v2, s[4:7], s20 offen offset:2048 lds
    buffer_load_dwordx4 v2, s[4:7], s20 offen offset:3072 lds
    s_add_u32 s20, s20, 32768
    buffer_load_dwordx4 v[8:11], v2, s[12:15], s27 offen offset:0
    buffer_load_dwordx4 v[12:15], v2, s[12:15], s27 offen offset:1024
    s_add_u32 m0, s25, 32768
    s_lshl_b32 s39, s16, 16
    s_add_u32 s45, s39, 16781312
    s_lshl_b32 s30, s18, 9
    s_add_u32 s39, s39, s30
    s_add_u32 s39, s39, 16777216
    s_lshr_b32 s76, s18, 2
    s_mul_i32 s76, s76, 1
    s_add_u32 s77, s76, 1
    s_add_u32 s78, s76, 2
    s_add_u32 s79, s76, 3
    s_add_u32 s80, s76, 4
    s_add_u32 s81, s76, 5
    s_lshl_b32 s31, s19, 5
    s_add_u32 s31, s31, s16
    s_lshl_b32 s31, s31, 11
    s_add_u32 s31, s31, 18874368
    s_add_u32 s41, s31, 4194304
    s_cmp_lt_u32 s2, 128
    s_cselect_b32 s8, s8, s36
    s_cselect_b32 s9, s9, s37
    s_mov_b32 s10, 2097152
    s_mov_b32 s90, 8388608
    s_mov_b32 s91, 0x00020000
    s_mov_b32 s11, 0x00020000
    s_bfe_u32 s27, s2, 0x40003
    s_lshl_b32 s27, s27, 2
    s_lshr_b32 s28, s18, 1
    s_add_u32 s27, s27, s28
    s_and_b32 s28, s2, 7
    s_lshl_b32 s28, s28, 1
    s_and_b32 s29, s18, 1
    s_add_u32 s28, s28, s29
    s_lshl_b32 s32, s27, 15
    s_lshl_b32 s29, s28, 7
    s_add_u32 s32, s32, s29
    s_add_u32 s33, s32, 15360
    s_lshr_b32 s29, s2, 7
    s_lshl_b32 s34, s29, 21
    s_lshl_b32 s29, s28, 17
    s_add_u32 s34, s34, s29
    s_lshl_b32 s29, s27, 10
    s_add_u32 s34, s34, s29
    s_add_u32 s34, s34, 27262976
    s_add_u32 s35, s34, 65536
    s_lshl_b32 s38, s18, 11
    s_add_u32 s38, s38, 135168
    v_lshrrev_b32 v3, 3, v1
    v_lshlrev_b32 v3, 11, v3
    v_and_b32 v4, 7, v1
    v_lshlrev_b32 v4, 4, v4
    v_add_u32 v7, v3, v4
    v_lshrrev_b32 v3, 5, v1
    v_lshlrev_b32 v200, 9, v3
    v_bfe_u32 v3, v1, 2, 2
    v_lshlrev_b32 v3, 7, v3
    v_add_u32 v200, v200, v3
    v_bfe_u32 v3, v1, 4, 1
    v_lshlrev_b32 v3, 5, v3
    v_add_u32 v200, v200, v3
    v_and_b32 v3, 3, v1
    v_lshlrev_b32 v3, 3, v3
    v_add_u32 v200, v200, v3
    v_add_u32 v200, s38, v200
    v_bfe_u32 v4, v1, 2, 1
    v_cmp_eq_u32 vcc, 0, v4
    v_mov_b32 v3, 0x3f803f80
    s_lshr_b32 s27, s18, 2
    s_lshl_b32 s27, s27, 10
    v_cndmask_b32 v132, 0, v3, vcc
    s_and_b32 s28, s18, 1
    s_lshl_b32 s28, s28, 9
    s_add_u32 s27, s27, s28
    s_and_b32 s28, s18, 2
    s_lshl_b32 s28, s28, 2
    s_add_u32 s27, s27, s28
    s_add_u32 s27, s27, 131072
    v_mov_b32 v133, v132
    v_xor_b32 v134, v132, v3
    v_xor_b32 v135, v132, v3
    v_and_b32 v207, 0x23, v1
    v_lshl_add_u32 v207, v4, 4, v207
    v_bfe_u32 v4, v1, 3, 2
    v_lshl_add_u32 v207, v4, 2, v207
    v_lshlrev_b32 v207, 4, v207
    v_and_b32 v3, 0x1f0, v2
    v_lshrrev_b32 v4, 5, v1
    v_lshl_add_u32 v208, v4, 13, v3
    v_lshl_add_u32 v201, v4, 2, v3
    v_add_u32 v201, s27, v201
    v_lshlrev_b32 v211, 4, v4
    v_add_u32 v211, 133120, v211
    v_lshlrev_b32 v210, 5, v4
    v_bfe_u32 v3, v1, 3, 1
    v_lshl_add_u32 v210, v3, 4, v210
    v_bfe_u32 v3, v1, 4, 1
    v_lshl_add_u32 v210, v3, 3, v210
    v_add_u32 v210, 133120, v210
    v_lshrrev_b32 v3, 3, v1
    v_lshlrev_b32 v209, 9, v3
    v_and_b32 v3, 7, v1
    v_lshl_add_u32 v209, v3, 13, v209
    v_add_u32 v202, 131072, v2
    s_mov_b32 s43, 0x358637bd
    s_mov_b32 s21, 0
    s_mov_b32 s22, 0
    s_mov_b32 s23, 32768
    s_mov_b32 s24, 98304
    v_mov_b32 v5, v2
    v_add_u32 v6, 32768, v2

    s_mov_b32 s92, s18
    s_mov_b32 s93, s2
    s_mov_b32 s94, -1
    s_lshl_b32 s95, s17, 5
    s_add_u32 s95, s95, s16
    s_lshl_b32 s95, s95, 5
    s_add_u32 s95, s95, 31457280
    s_and_b32 s96, s2, 31
    s_lshl_b32 s96, s96, 8
    s_add_u32 s96, s96, 31555584
    s_mov_b32 s97, 2000
    s_lshr_b32 s99, s2, 7
    s_lshl_b32 s99, s99, 3
    s_and_b32 s27, s2, 7
    s_add_u32 s99, s99, s27
    s_lshl_b32 s99, s99, 4
    s_bfe_u32 s27, s2, 0x40003
    s_add_u32 s99, s99, s27
    s_lshl_b32 s99, s99, 5
    s_add_u32 s99, s99, 31522816

    v_mov_b32 v96, 0
    v_mov_b32 v97, 0
    v_mov_b32 v98, 0
    v_mov_b32 v99, 0
    v_mov_b32 v100, 0
    v_mov_b32 v101, 0
    v_mov_b32 v102, 0
    v_mov_b32 v103, 0
    v_mov_b32 v104, 0
    v_mov_b32 v105, 0
    v_mov_b32 v106, 0
    v_mov_b32 v107, 0
    v_mov_b32 v108, 0
    v_mov_b32 v109, 0
    v_mov_b32 v110, 0
    v_mov_b32 v111, 0
    v_mov_b32 v128, 0
    v_mov_b32 v129, 0
    v_mov_b32 v130, 0
    v_mov_b32 v131, 0
    v_mov_b32 v72, 0
    v_mov_b32 v73, 0
    v_mov_b32 v74, 0
    v_mov_b32 v75, 0
    v_mov_b32 v76, 0
    v_mov_b32 v77, 0
    v_mov_b32 v78, 0
    v_mov_b32 v79, 0
    v_mov_b32 v44, 0
    v_mov_b32 v45, 0
    v_mov_b32 v46, 0
    v_mov_b32 v47, 0
    v_mov_b32 v206, 0xdddddddd

    s_waitcnt vmcnt(0)

    s_barrier

    ds_read_b128 v[16:19], v2 offset:0
    ds_read_b128 v[20:23], v2 offset:1024
    ds_read_b128 v[24:27], v2 offset:4096
    ds_read_b128 v[28:31], v2 offset:5120
    ds_read_b128 v[32:35], v2 offset:2048
    ds_read_b128 v[36:39], v2 offset:3072
    buffer_load_dwordx4 v214, s[4:7], s20 offen offset:0 lds
    buffer_load_dwordx4 v214, s[4:7], s20 offen offset:1024 lds
    s_waitcnt lgkmcnt(4)
    v_mfma_f32_32x32x16_bf16 v[48:63], v[16:19], v[8:11], 0
    v_mfma_f32_32x32x16_bf16 v[48:63], v[20:23], v[12:15], v[48:63]

    buffer_load_dwordx4 v2, s[4:7], s20 offen offset:2048 lds
    buffer_load_dwordx4 v2, s[4:7], s20 offen offset:3072 lds
    s_add_u32 s20, s20, 32768
    s_add_u32 m0, s25, 65536
    s_nop 8

    v_max3_f32 v3, v48, v49, v50
    v_max3_f32 v4, v51, v52, v53
    v_max3_f32 v3, v3, v54, v55
    v_max3_f32 v4, v4, v56, v57
    v_max3_f32 v3, v3, v58, v59
    v_max3_f32 v4, v4, v60, v61
    v_max3_f32 v3, v3, v62, v63
    v_max_f32 v3, v3, v4
    v_mov_b32 v4, v3
    s_nop 1
    v_permlane32_swap_b32 v3, v4
    s_nop 1
    v_max_f32 v3, v3, v4

    buffer_load_dwordx4 v214, s[4:7], s20 offen offset:0 lds
    buffer_load_dwordx4 v214, s[4:7], s20 offen offset:1024 lds
    v_sub_f32 v80, 0, v3
    v_sub_f32 v81, 0, v3
    v_sub_f32 v82, 0, v3
    v_sub_f32 v83, 0, v3
    v_sub_f32 v84, 0, v3
    v_sub_f32 v85, 0, v3
    v_sub_f32 v86, 0, v3
    v_sub_f32 v87, 0, v3
    v_sub_f32 v88, 0, v3
    v_sub_f32 v89, 0, v3
    v_sub_f32 v90, 0, v3
    v_sub_f32 v91, 0, v3
    v_sub_f32 v92, 0, v3
    v_sub_f32 v93, 0, v3
    v_sub_f32 v94, 0, v3
    v_sub_f32 v95, 0, v3
    v_sub_f32 v48, v48, v3
    v_sub_f32 v49, v49, v3
    v_sub_f32 v50, v50, v3
    v_sub_f32 v51, v51, v3
    v_sub_f32 v52, v52, v3
    v_sub_f32 v53, v53, v3
    v_sub_f32 v54, v54, v3
    v_sub_f32 v55, v55, v3
    v_sub_f32 v56, v56, v3
    v_sub_f32 v57, v57, v3
    v_sub_f32 v58, v58, v3
    v_sub_f32 v59, v59, v3
    v_sub_f32 v60, v60, v3
    v_sub_f32 v61, v61, v3
    v_sub_f32 v62, v62, v3
    v_sub_f32 v63, v63, v3
k2_loop:
    s_waitcnt lgkmcnt(0)
    v_exp_f32 v48, v48
    v_exp_f32 v49, v49
    v_smfmac_f32_32x32x32_bf16 v[96:111], v[44:47], v[72:79], v206
    ds_read_b128 v[16:19], v5 offset:8192
    ds_read_b128 v[20:23], v5 offset:9216
    v_exp_f32 v50, v50
    v_exp_f32 v51, v51
    v_exp_f32 v52, v52
    v_smfmac_f32_16x16x64_bf16 v[128:131], v[132:135], v[72:79], v206
    buffer_load_dwordx4 v2, s[4:7], s20 offen offset:2048 lds
    v_exp_f32 v53, v53
    v_exp_f32 v54, v54
    v_mfma_f32_32x32x16_bf16 v[64:79], v[24:27], v[8:11], v[80:95]
    ds_read_b128 v[40:43], v5 offset:6144
    ds_read_b128 v[44:47], v5 offset:7168
    v_exp_f32 v55, v55
    v_exp_f32 v56, v56
    v_exp_f32 v57, v57
    v_mfma_f32_32x32x16_bf16 v[64:79], v[28:31], v[12:15], v[64:79]
    v_exp_f32 v58, v58
    v_exp_f32 v59, v59
    v_exp_f32 v60, v60
    v_smfmac_f32_32x32x32_bf16 v[96:111], v[32:35], v[48:55], v206
    v_exp_f32 v61, v61
    v_exp_f32 v62, v62
    v_exp_f32 v63, v63
    v_smfmac_f32_16x16x64_bf16 v[128:131], v[132:135], v[48:55], v206
    s_cmp_eq_u32 s21, s78
    s_cbranch_scc1 k2_side_0
k2_back_0:
    s_waitcnt lgkmcnt(0)
    v_exp_f32 v64, v64
    v_exp_f32 v65, v65
    v_smfmac_f32_32x32x32_bf16 v[96:111], v[36:39], v[56:63], v206
    ds_read_b128 v[24:27], v5 offset:12288
    ds_read_b128 v[28:31], v5 offset:13312
    v_exp_f32 v66, v66
    v_exp_f32 v67, v67
    v_exp_f32 v68, v68
    v_smfmac_f32_16x16x64_bf16 v[128:131], v[132:135], v[56:63], v206
    buffer_load_dwordx4 v2, s[4:7], s20 offen offset:3072 lds
    s_add_u32 s20, s20, 32768
    v_exp_f32 v69, v69
    v_exp_f32 v70, v70
    v_mfma_f32_32x32x16_bf16 v[48:63], v[16:19], v[8:11], v[80:95]
    ds_read_b128 v[32:35], v5 offset:10240
    ds_read_b128 v[36:39], v5 offset:11264
    v_exp_f32 v71, v71
    v_exp_f32 v72, v72
    v_exp_f32 v73, v73
    v_mfma_f32_32x32x16_bf16 v[48:63], v[20:23], v[12:15], v[48:63]
    v_exp_f32 v74, v74
    v_exp_f32 v75, v75
    v_exp_f32 v76, v76
    v_smfmac_f32_32x32x32_bf16 v[96:111], v[40:43], v[64:71], v206
    v_exp_f32 v77, v77
    v_exp_f32 v78, v78
    v_exp_f32 v79, v79
    v_smfmac_f32_16x16x64_bf16 v[128:131], v[132:135], v[64:71], v206
    s_cmp_eq_u32 s21, s80
    s_cbranch_scc1 k2_side_1
k2_back_1:
    s_waitcnt lgkmcnt(0)
    v_exp_f32 v48, v48
    v_exp_f32 v49, v49
    v_smfmac_f32_32x32x32_bf16 v[96:111], v[44:47], v[72:79], v206
    ds_read_b128 v[16:19], v5 offset:16384
    ds_read_b128 v[20:23], v5 offset:17408
    v_exp_f32 v50, v50
    v_exp_f32 v51, v51
    v_exp_f32 v52, v52
    v_smfmac_f32_16x16x64_bf16 v[128:131], v[132:135], v[72:79], v206
    v_exp_f32 v53, v53
    v_exp_f32 v54, v54
    v_mfma_f32_32x32x16_bf16 v[64:79], v[24:27], v[8:11], v[80:95]
    ds_read_b128 v[40:43], v5 offset:14336
    ds_read_b128 v[44:47], v5 offset:15360
    v_exp_f32 v55, v55
    v_exp_f32 v56, v56
    v_exp_f32 v57, v57
    v_mfma_f32_32x32x16_bf16 v[64:79], v[28:31], v[12:15], v[64:79]
    v_exp_f32 v58, v58
    v_exp_f32 v59, v59
    v_exp_f32 v60, v60
    v_smfmac_f32_32x32x32_bf16 v[96:111], v[32:35], v[48:55], v206
    v_exp_f32 v61, v61
    v_exp_f32 v62, v62
    v_exp_f32 v63, v63
    v_smfmac_f32_16x16x64_bf16 v[128:131], v[132:135], v[48:55], v206
    s_waitcnt lgkmcnt(0)
    v_exp_f32 v64, v64
    v_exp_f32 v65, v65
    v_smfmac_f32_32x32x32_bf16 v[96:111], v[36:39], v[56:63], v206
    ds_read_b128 v[24:27], v5 offset:20480
    ds_read_b128 v[28:31], v5 offset:21504
    v_exp_f32 v66, v66
    v_exp_f32 v67, v67
    v_exp_f32 v68, v68
    v_smfmac_f32_16x16x64_bf16 v[128:131], v[132:135], v[56:63], v206
    v_exp_f32 v69, v69
    v_exp_f32 v70, v70
    v_mfma_f32_32x32x16_bf16 v[48:63], v[16:19], v[8:11], v[80:95]
    ds_read_b128 v[32:35], v5 offset:18432
    ds_read_b128 v[36:39], v5 offset:19456
    v_exp_f32 v71, v71
    v_exp_f32 v72, v72
    v_exp_f32 v73, v73
    v_mfma_f32_32x32x16_bf16 v[48:63], v[20:23], v[12:15], v[48:63]
    v_exp_f32 v74, v74
    v_exp_f32 v75, v75
    v_exp_f32 v76, v76
    v_smfmac_f32_32x32x32_bf16 v[96:111], v[40:43], v[64:71], v206
    v_exp_f32 v77, v77
    v_exp_f32 v78, v78
    v_exp_f32 v79, v79
    v_smfmac_f32_16x16x64_bf16 v[128:131], v[132:135], v[64:71], v206
    s_cmp_eq_u32 s21, s80
    s_cbranch_scc1 k2_side_3
k2_back_3:
    s_waitcnt lgkmcnt(0)
    v_exp_f32 v48, v48
    v_exp_f32 v49, v49
    v_smfmac_f32_32x32x32_bf16 v[96:111], v[44:47], v[72:79], v206
    ds_read_b128 v[16:19], v5 offset:24576
    ds_read_b128 v[20:23], v5 offset:25600
    v_exp_f32 v50, v50
    v_exp_f32 v51, v51
    v_exp_f32 v52, v52
    v_smfmac_f32_16x16x64_bf16 v[128:131], v[132:135], v[72:79], v206
    v_exp_f32 v53, v53
    v_exp_f32 v54, v54
    v_mfma_f32_32x32x16_bf16 v[64:79], v[24:27], v[8:11], v[80:95]
    ds_read_b128 v[40:43], v5 offset:22528
    ds_read_b128 v[44:47], v5 offset:23552
    v_exp_f32 v55, v55
    v_exp_f32 v56, v56
    v_exp_f32 v57, v57
    v_mfma_f32_32x32x16_bf16 v[64:79], v[28:31], v[12:15], v[64:79]
    v_exp_f32 v58, v58
    v_exp_f32 v59, v59
    v_exp_f32 v60, v60
    v_smfmac_f32_32x32x32_bf16 v[96:111], v[32:35], v[48:55], v206
    v_exp_f32 v61, v61
    v_exp_f32 v62, v62
    v_exp_f32 v63, v63
    v_smfmac_f32_16x16x64_bf16 v[128:131], v[132:135], v[48:55], v206
    s_cmp_eq_u32 s21, s76
    s_cbranch_scc1 k2_side_4
k2_back_4:
    s_waitcnt lgkmcnt(0)
    v_exp_f32 v64, v64
    v_exp_f32 v65, v65
    v_smfmac_f32_32x32x32_bf16 v[96:111], v[36:39], v[56:63], v206
    ds_read_b128 v[24:27], v5 offset:28672
    ds_read_b128 v[28:31], v5 offset:29696
    v_exp_f32 v66, v66
    v_exp_f32 v67, v67
    v_exp_f32 v68, v68
    v_smfmac_f32_16x16x64_bf16 v[128:131], v[132:135], v[56:63], v206
    v_exp_f32 v69, v69
    v_exp_f32 v70, v70
    v_mfma_f32_32x32x16_bf16 v[48:63], v[16:19], v[8:11], v[80:95]
    ds_read_b128 v[32:35], v5 offset:26624
    ds_read_b128 v[36:39], v5 offset:27648
    v_exp_f32 v71, v71
    v_exp_f32 v72, v72
    v_exp_f32 v73, v73
    v_mfma_f32_32x32x16_bf16 v[48:63], v[20:23], v[12:15], v[48:63]
    v_exp_f32 v74, v74
    v_exp_f32 v75, v75
    v_exp_f32 v76, v76
    v_smfmac_f32_32x32x32_bf16 v[96:111], v[40:43], v[64:71], v206
    v_exp_f32 v77, v77
    v_exp_f32 v78, v78
    v_exp_f32 v79, v79
    v_smfmac_f32_16x16x64_bf16 v[128:131], v[132:135], v[64:71], v206
    s_waitcnt vmcnt(4) lgkmcnt(0)
    s_barrier
    v_exp_f32 v48, v48
    v_exp_f32 v49, v49
    v_smfmac_f32_32x32x32_bf16 v[96:111], v[44:47], v[72:79], v206
    s_add_u32 m0, s24, s25
    s_cmp_lt_u32 s21, 5
    s_cselect_b32 s6, s26, 0
    ds_read_b128 v[16:19], v6 offset:0
    ds_read_b128 v[20:23], v6 offset:1024
    v_exp_f32 v50, v50
    v_exp_f32 v51, v51
    v_exp_f32 v52, v52
    v_smfmac_f32_16x16x64_bf16 v[128:131], v[132:135], v[72:79], v206
    buffer_load_dwordx4 v214, s[4:7], s20 offen offset:0 lds
    v_exp_f32 v53, v53
    v_exp_f32 v54, v54
    v_mfma_f32_32x32x16_bf16 v[64:79], v[24:27], v[8:11], v[80:95]
    ds_read_b128 v[40:43], v5 offset:30720
    ds_read_b128 v[44:47], v5 offset:31744
    v_exp_f32 v55, v55
    v_exp_f32 v56, v56
    v_exp_f32 v57, v57
    v_mfma_f32_32x32x16_bf16 v[64:79], v[28:31], v[12:15], v[64:79]
    v_exp_f32 v58, v58
    v_exp_f32 v59, v59
    v_exp_f32 v60, v60
    v_smfmac_f32_32x32x32_bf16 v[96:111], v[32:35], v[48:55], v206
    v_exp_f32 v61, v61
    v_exp_f32 v62, v62
    v_exp_f32 v63, v63
    v_smfmac_f32_16x16x64_bf16 v[128:131], v[132:135], v[48:55], v206
    s_cmp_eq_u32 s21, s79
    s_cbranch_scc1 k2_side_6
k2_back_6:
    s_waitcnt lgkmcnt(0)
    v_exp_f32 v64, v64
    v_exp_f32 v65, v65
    v_smfmac_f32_32x32x32_bf16 v[96:111], v[36:39], v[56:63], v206
    ds_read_b128 v[24:27], v6 offset:4096
    ds_read_b128 v[28:31], v6 offset:5120
    v_exp_f32 v66, v66
    v_exp_f32 v67, v67
    v_exp_f32 v68, v68
    v_smfmac_f32_16x16x64_bf16 v[128:131], v[132:135], v[56:63], v206
    buffer_load_dwordx4 v214, s[4:7], s20 offen offset:1024 lds
    v_exp_f32 v69, v69
    v_exp_f32 v70, v70
    v_mfma_f32_32x32x16_bf16 v[48:63], v[16:19], v[8:11], v[80:95]
    ds_read_b128 v[32:35], v6 offset:2048
    ds_read_b128 v[36:39], v6 offset:3072
    v_exp_f32 v71, v71
    v_exp_f32 v72, v72
    v_exp_f32 v73, v73
    v_mfma_f32_32x32x16_bf16 v[48:63], v[20:23], v[12:15], v[48:63]
    v_exp_f32 v74, v74
    v_exp_f32 v75, v75
    v_exp_f32 v76, v76
    v_smfmac_f32_32x32x32_bf16 v[96:111], v[40:43], v[64:71], v206
    v_exp_f32 v77, v77
    v_exp_f32 v78, v78
    v_exp_f32 v79, v79
    v_smfmac_f32_16x16x64_bf16 v[128:131], v[132:135], v[64:71], v206
    s_cmp_eq_u32 s21, s76
    s_cbranch_scc1 k2_side_7
k2_back_7:
    s_mov_b32 s24, s22
    s_mov_b32 s22, s23
    s_add_u32 s23, s23, 32768
    s_and_b32 s23, s23, 131071
    v_mov_b32 v5, v6
    v_add_u32 v6, s23, v2
    s_add_u32 s21, s21, 1

    s_cmp_lt_u32 s21, 8
    s_cbranch_scc1 k2_loop
    s_nop 0
    v_smfmac_f32_32x32x32_bf16 v[96:111], v[44:47], v[72:79], v206
    v_smfmac_f32_16x16x64_bf16 v[128:131], v[132:135], v[72:79], v206
    s_mov_b32 s27, 0x53800000
    s_nop 8
    v_cmp_nle_f32 vcc, v128, s27
    s_cbranch_vccnz k2_fallback

k2_fin:
    v_rcp_f32 v3, v128
    s_nop 0

    v_mul_f32 v96, v96, v3
    v_mul_f32 v97, v97, v3
    v_mul_f32 v98, v98, v3
    v_mul_f32 v99, v99, v3
    v_mul_f32 v100, v100, v3
    v_mul_f32 v101, v101, v3
    v_mul_f32 v102, v102, v3
    v_mul_f32 v103, v103, v3
    v_mul_f32 v104, v104, v3
    v_mul_f32 v105, v105, v3
    v_mul_f32 v106, v106, v3
    v_mul_f32 v107, v107, v3
    v_mul_f32 v108, v108, v3
    v_mul_f32 v109, v109, v3
    v_mul_f32 v110, v110, v3
    v_mul_f32 v111, v111, v3
    v_cvt_pk_bf16_f32 v112, v96, v97
    v_cvt_pk_bf16_f32 v113, v98, v99
    v_cvt_pk_bf16_f32 v114, v100, v101
    v_cvt_pk_bf16_f32 v115, v102, v103
    v_cvt_pk_bf16_f32 v116, v104, v105
    v_cvt_pk_bf16_f32 v117, v106, v107
    v_cvt_pk_bf16_f32 v118, v108, v109
    v_cvt_pk_bf16_f32 v119, v110, v111
    buffer_store_dwordx4 v[112:115], v2, s[12:15], s31 offen offset:0 sc1
    buffer_store_dwordx4 v[116:119], v2, s[12:15], s31 offen offset:1024 sc1
    v_mov_b32 v209, 1
    v_lshlrev_b32 v211, 2, v1
    v_mov_b32 v3, 131072

k3_tile:
    s_and_b32 s29, s93, 7
    s_lshr_b32 s30, s93, 3
    s_lshr_b32 s16, s29, 2
    s_bfe_u32 s31, s29, 0x10001
    s_lshl_b32 s31, s31, 3
    s_lshr_b32 s32, s30, 2
    s_add_u32 s17, s31, s32
    s_and_b32 s31, s29, 1
    s_lshl_b32 s31, s31, 2
    s_and_b32 s32, s30, 3
    s_add_u32 s18, s31, s32
    s_cmp_lt_u32 s92, 4
    s_cbranch_scc1 k3_compute

    s_and_b32 s19, s92, 3
    s_lshl_b32 s29, s17, 2
    s_add_u32 s29, s29, s19
    s_lshl_b32 s22, s29, 16
    s_lshl_b32 s29, s16, 22
    s_add_u32 s22, s22, s29
    s_add_u32 s22, s22, 18874368
    s_lshl_b32 s29, s18, 2
    s_add_u32 s29, s29, s19
    s_lshl_b32 s23, s29, 16
    s_lshl_b32 s29, s16, 21
    s_add_u32 s23, s23, s29
    s_add_u32 s23, s23, 27262976
    s_lshl_b32 s27, s19, 12
    s_mov_b32 s26, s27
    s_add_u32 s28, s27, 131072
    s_lshr_b32 s29, s17, 1
    s_lshl_b32 s29, s29, 10
    s_lshl_b32 s30, s16, 15
    s_add_u32 s29, s29, s30
    s_lshl_b32 s30, s16, 3
    s_add_u32 s30, s30, s18
    s_lshl_b32 s30, s30, 9
    s_add_u32 s30, s30, 65536
    v_lshlrev_b32 v210, 5, v1
    v_and_b32 v5, 15, v1
    v_add_u32 v210, s29, v210
    v_lshlrev_b32 v5, 5, v5
    s_mov_b32 exec_lo, 0
    v_add_u32 v210, s30, v5
    s_mov_b32 exec_lo, -1
    v_mov_b32 v4, 0
    s_mov_b32 s98, 0
    s_mov_b32 s31, 31457280
    s_waitcnt vmcnt(0) lgkmcnt(0)
    s_barrier
    s_cmp_lg_u32 s92, 4
    s_cbranch_scc1 k3_ld_wait
    s_mov_b64 exec, 1
    buffer_store_dword v209, v4, s[12:15], s95 offen sc1
    s_mov_b64 exec, -1
    buffer_load_dword v10, v210, s[12:15], s31 offen sc1
    ds_write_b32 v3, v4

k3_poll:
    s_waitcnt vmcnt(0)
    v_cmp_ne_u32 vcc, 1, v10
    s_cbranch_vccz k3_ld_wait
    buffer_load_dword v10, v210, s[12:15], s31 offen sc1
    s_add_u32 s98, s98, 1
    s_cmp_lt_u32 s98, s97
    s_cbranch_scc1 k3_poll
    ds_write_b32 v3, v209
    s_cmp_ge_i32 s94, 0
    s_cbranch_scc1 k3_ld_wait
    v_lshlrev_b32 v5, 8, v1
    s_add_u32 s29, s2, 31555584
    s_mov_b32 exec_hi, 0
    buffer_store_byte v209, v5, s[12:15], s29 offen sc1
    s_mov_b32 exec_hi, -1
    s_waitcnt vmcnt(0)
    buffer_load_dword v10, v211, s[12:15], s96 offen sc1
    v_add_u32 v5, 131328, v211
    s_waitcnt vmcnt(0)
    ds_write_b32 v5, v10

k3_ld_wait:
    s_waitcnt vmcnt(0) lgkmcnt(0)
    s_barrier
    ds_read_b32 v4, v3
    s_waitcnt lgkmcnt(0)
    v_cmp_ne_u32 vcc, 0, v4
    s_cbranch_vccnz k3_skip
    s_cmp_lg_u32 s92, 4
    s_cbranch_scc1 k3_ld_go
    buffer_load_dword v10, v211, s[12:15], s96 offen sc1

k3_ld_go:
    s_mov_b32 m0, s26
    s_nop 0
    buffer_load_dwordx4 v2, s[12:15], s22 offen offset:0 sc1 lds
    buffer_load_dwordx4 v2, s[12:15], s22 offen offset:1024 sc1 lds
    buffer_load_dwordx4 v2, s[12:15], s22 offen offset:2048 sc1 lds
    buffer_load_dwordx4 v2, s[12:15], s22 offen offset:3072 sc1 lds
    s_add_u32 m0, s26, 16384
    s_add_u32 s22, s22, 4096
    buffer_load_dwordx4 v2, s[12:15], s23 offen offset:0 sc1 lds
    buffer_load_dwordx4 v2, s[12:15], s23 offen offset:1024 sc1 lds
    buffer_load_dwordx4 v2, s[12:15], s23 offen offset:2048 sc1 lds
    buffer_load_dwordx4 v2, s[12:15], s23 offen offset:3072 sc1 lds
    s_add_u32 s23, s23, 4096
    s_add_u32 s26, s26, 32768
    s_cmp_eq_u32 s26, s28
    s_cselect_b32 s26, s27, s26
    s_mov_b32 m0, s26
    s_nop 0
    buffer_load_dwordx4 v2, s[12:15], s22 offen offset:0 sc1 lds
    buffer_load_dwordx4 v2, s[12:15], s22 offen offset:1024 sc1 lds
    buffer_load_dwordx4 v2, s[12:15], s22 offen offset:2048 sc1 lds
    buffer_load_dwordx4 v2, s[12:15], s22 offen offset:3072 sc1 lds
    s_add_u32 m0, s26, 16384
    s_add_u32 s22, s22, 4096
    buffer_load_dwordx4 v2, s[12:15], s23 offen offset:0 sc1 lds
    buffer_load_dwordx4 v2, s[12:15], s23 offen offset:1024 sc1 lds
    buffer_load_dwordx4 v2, s[12:15], s23 offen offset:2048 sc1 lds
    buffer_load_dwordx4 v2, s[12:15], s23 offen offset:3072 sc1 lds
    s_add_u32 s23, s23, 4096
    s_add_u32 s26, s26, 32768
    s_cmp_eq_u32 s26, s28
    s_cselect_b32 s26, s27, s26
    s_mov_b32 s24, 0
k3_ld:
    s_waitcnt vmcnt(8)
    s_barrier
    s_mov_b32 m0, s26
    s_nop 0
    buffer_load_dwordx4 v2, s[12:15], s22 offen offset:0 sc1 lds
    buffer_load_dwordx4 v2, s[12:15], s22 offen offset:1024 sc1 lds
    buffer_load_dwordx4 v2, s[12:15], s22 offen offset:2048 sc1 lds
    buffer_load_dwordx4 v2, s[12:15], s22 offen offset:3072 sc1 lds
    s_add_u32 m0, s26, 16384
    s_add_u32 s22, s22, 4096
    buffer_load_dwordx4 v2, s[12:15], s23 offen offset:0 sc1 lds
    buffer_load_dwordx4 v2, s[12:15], s23 offen offset:1024 sc1 lds
    buffer_load_dwordx4 v2, s[12:15], s23 offen offset:2048 sc1 lds
    buffer_load_dwordx4 v2, s[12:15], s23 offen offset:3072 sc1 lds
    s_add_u32 s23, s23, 4096
    s_add_u32 s26, s26, 32768
    s_cmp_eq_u32 s26, s28
    s_cselect_b32 s26, s27, s26
    s_add_u32 s24, s24, 1
    s_cmp_lt_u32 s24, 14
    s_cbranch_scc1 k3_ld

    v_add_u32 v4, 131328, v211
    s_cmp_ge_i32 s94, 0
    s_cbranch_scc1 k3_ld_nost
    s_cmp_lg_u32 s92, 4
    s_cbranch_scc1 k3_ld_nost
    ds_write_b32 v4, v10

k3_ld_nost:
    s_waitcnt vmcnt(8) lgkmcnt(0)
    s_barrier
    s_waitcnt vmcnt(0) lgkmcnt(0)
    s_barrier
    s_cmp_ge_i32 s94, 0
    s_cbranch_scc1 k3_next
    ds_read_b32 v208, v4
    s_branch k3_chk

k3_compute:
    s_and_b32 s20, s92, 1
    s_lshr_b32 s21, s92, 1
    s_lshl_b32 s29, s20, 13
    s_lshl_b32 s30, s21, 13
    s_add_u32 s30, s30, 16384
    v_lshrrev_b32 v5, 4, v1
    v_and_b32 v6, 15, v1
    v_lshlrev_b32 v9, 9, v5
    v_lshl_add_u32 v9, v6, 4, v9
    v_add_u32 v7, s29, v9
    v_add_u32 v8, s30, v9
    v_lshlrev_b32 v9, 12, v6
    v_lshl_add_u32 v9, v5, 4, v9
    v_mov_b32 v5, v7
    v_mov_b32 v6, v8
    s_mov_b32 s24, 0
    s_mov_b32 s25, 0
    s_lshl_b32 s29, s17, 7
    s_lshl_b32 s30, s20, 6
    s_add_u32 s29, s29, s30
    s_lshl_b32 s29, s29, 12
    s_lshl_b32 s30, s16, 11
    s_add_u32 s29, s29, s30
    s_lshl_b32 s30, s18, 8
    s_add_u32 s29, s29, s30
    s_lshl_b32 s30, s21, 7
    s_add_u32 s29, s29, s30
    s_add_u32 s30, s29, 65536
    s_add_u32 s31, s29, 131072
    s_add_u32 s32, s29, 196608
    v_add_u32 v10, 131328, v211

    v_and_b32 v11, 7, v1
    v_lshlrev_b32 v11, 12, v11
    v_bfe_u32 v12, v1, 3, 1
    v_lshl_add_u32 v11, v12, 6, v11
    v_lshrrev_b32 v12, 4, v1
    v_lshl_add_u32 v11, v12, 4, v11
    v_add_u32 v12, 0x8000, v11

    v_mov_b32 v144, 0
    v_mov_b32 v145, 0
    v_mov_b32 v146, 0
    v_mov_b32 v147, 0
    v_mov_b32 v148, 0
    v_mov_b32 v149, 0
    v_mov_b32 v150, 0
    v_mov_b32 v151, 0
    v_mov_b32 v152, 0
    v_mov_b32 v153, 0
    v_mov_b32 v154, 0
    v_mov_b32 v155, 0
    v_mov_b32 v156, 0
    v_mov_b32 v157, 0
    v_mov_b32 v158, 0
    v_mov_b32 v159, 0
    v_mov_b32 v160, 0
    v_mov_b32 v161, 0
    v_mov_b32 v162, 0
    v_mov_b32 v163, 0
    v_mov_b32 v164, 0
    v_mov_b32 v165, 0
    v_mov_b32 v166, 0
    v_mov_b32 v167, 0
    v_mov_b32 v168, 0
    v_mov_b32 v169, 0
    v_mov_b32 v170, 0
    v_mov_b32 v171, 0
    v_mov_b32 v172, 0
    v_mov_b32 v173, 0
    v_mov_b32 v174, 0
    v_mov_b32 v175, 0
    v_mov_b32 v176, 0
    v_mov_b32 v177, 0
    v_mov_b32 v178, 0
    v_mov_b32 v179, 0
    v_mov_b32 v180, 0
    v_mov_b32 v181, 0
    v_mov_b32 v182, 0
    v_mov_b32 v183, 0
    v_mov_b32 v184, 0
    v_mov_b32 v185, 0
    v_mov_b32 v186, 0
    v_mov_b32 v187, 0
    v_mov_b32 v188, 0
    v_mov_b32 v189, 0
    v_mov_b32 v190, 0
    v_mov_b32 v191, 0
    v_mov_b32 v192, 0
    v_mov_b32 v193, 0
    v_mov_b32 v194, 0
    v_mov_b32 v195, 0
    v_mov_b32 v196, 0
    v_mov_b32 v197, 0
    v_mov_b32 v198, 0
    v_mov_b32 v199, 0
    v_mov_b32 v200, 0
    v_mov_b32 v201, 0
    v_mov_b32 v202, 0
    v_mov_b32 v203, 0
    v_mov_b32 v204, 0
    v_mov_b32 v205, 0
    v_mov_b32 v206, 0
    v_mov_b32 v207, 0
    s_waitcnt vmcnt(0) lgkmcnt(0)

    s_barrier
    s_barrier

    ds_read_b32 v4, v3
    s_waitcnt lgkmcnt(0)
    v_cmp_ne_u32 vcc, 0, v4
    s_cbranch_vccnz k3_skip

    s_barrier

    ds_read_b128 v[16:19], v5 offset:0
    ds_read_b128 v[32:35], v6 offset:0
    ds_read_b128 v[20:23], v5 offset:256
    ds_read_b128 v[36:39], v6 offset:256
    ds_read_b128 v[24:27], v5 offset:4096
    ds_read_b128 v[40:43], v6 offset:4096
    ds_read_b128 v[28:31], v5 offset:4352
    ds_read_b128 v[44:47], v6 offset:4352
    ds_read_b128 v[48:51], v5 offset:2048
    ds_read_b128 v[64:67], v6 offset:2048
    ds_read_b128 v[52:55], v5 offset:2304
    ds_read_b128 v[68:71], v6 offset:2304
    ds_read_b128 v[56:59], v5 offset:6144
    ds_read_b128 v[72:75], v6 offset:6144
    ds_read_b128 v[60:63], v5 offset:6400
    ds_read_b128 v[76:79], v6 offset:6400
    s_add_u32 s25, s25, 32768
    s_cmp_eq_u32 s25, 131072
    s_cselect_b32 s25, 0, s25
    v_add_u32 v5, s25, v7
    v_add_u32 v6, s25, v8
k3_loop:
    s_waitcnt lgkmcnt(0)
    s_barrier
    v_mfma_f32_16x16x32_bf16 v[144:147], v[32:35], v[16:19], v[144:147]
    ds_read_b128 v[80:83], v5 offset:0
    v_mfma_f32_16x16x32_bf16 v[148:151], v[36:39], v[16:19], v[148:151]
    ds_read_b128 v[96:99], v6 offset:0
    v_mfma_f32_16x16x32_bf16 v[160:163], v[40:43], v[16:19], v[160:163]
    ds_read_b128 v[84:87], v5 offset:256
    v_mfma_f32_16x16x32_bf16 v[164:167], v[44:47], v[16:19], v[164:167]
    ds_read_b128 v[100:103], v6 offset:256
    v_mfma_f32_16x16x32_bf16 v[152:155], v[32:35], v[20:23], v[152:155]
    ds_read_b128 v[88:91], v5 offset:4096
    v_mfma_f32_16x16x32_bf16 v[156:159], v[36:39], v[20:23], v[156:159]
    ds_read_b128 v[104:107], v6 offset:4096
    v_mfma_f32_16x16x32_bf16 v[168:171], v[40:43], v[20:23], v[168:171]
    ds_read_b128 v[92:95], v5 offset:4352
    v_mfma_f32_16x16x32_bf16 v[172:175], v[44:47], v[20:23], v[172:175]
    ds_read_b128 v[108:111], v6 offset:4352
    v_mfma_f32_16x16x32_bf16 v[176:179], v[32:35], v[24:27], v[176:179]
    ds_read_b128 v[112:115], v5 offset:2048
    v_mfma_f32_16x16x32_bf16 v[180:183], v[36:39], v[24:27], v[180:183]
    ds_read_b128 v[128:131], v6 offset:2048
    v_mfma_f32_16x16x32_bf16 v[192:195], v[40:43], v[24:27], v[192:195]
    ds_read_b128 v[116:119], v5 offset:2304
    v_mfma_f32_16x16x32_bf16 v[196:199], v[44:47], v[24:27], v[196:199]
    ds_read_b128 v[132:135], v6 offset:2304
    v_mfma_f32_16x16x32_bf16 v[184:187], v[32:35], v[28:31], v[184:187]
    ds_read_b128 v[120:123], v5 offset:6144
    v_mfma_f32_16x16x32_bf16 v[188:191], v[36:39], v[28:31], v[188:191]
    ds_read_b128 v[136:139], v6 offset:6144
    v_mfma_f32_16x16x32_bf16 v[200:203], v[40:43], v[28:31], v[200:203]
    ds_read_b128 v[124:127], v5 offset:6400
    v_mfma_f32_16x16x32_bf16 v[204:207], v[44:47], v[28:31], v[204:207]
    ds_read_b128 v[140:143], v6 offset:6400
    v_mfma_f32_16x16x32_bf16 v[144:147], v[64:67], v[48:51], v[144:147]
    v_mfma_f32_16x16x32_bf16 v[148:151], v[68:71], v[48:51], v[148:151]
    v_mfma_f32_16x16x32_bf16 v[160:163], v[72:75], v[48:51], v[160:163]
    v_mfma_f32_16x16x32_bf16 v[164:167], v[76:79], v[48:51], v[164:167]
    v_mfma_f32_16x16x32_bf16 v[152:155], v[64:67], v[52:55], v[152:155]
    s_add_u32 s25, s25, 32768
    s_cmp_eq_u32 s25, 131072
    s_cselect_b32 s25, 0, s25
    v_add_u32 v5, s25, v7
    v_add_u32 v6, s25, v8
    s_add_u32 s24, s24, 1
    v_mfma_f32_16x16x32_bf16 v[156:159], v[68:71], v[52:55], v[156:159]
    v_mfma_f32_16x16x32_bf16 v[168:171], v[72:75], v[52:55], v[168:171]
    v_mfma_f32_16x16x32_bf16 v[172:175], v[76:79], v[52:55], v[172:175]
    v_mfma_f32_16x16x32_bf16 v[176:179], v[64:67], v[56:59], v[176:179]
    v_mfma_f32_16x16x32_bf16 v[180:183], v[68:71], v[56:59], v[180:183]
    v_mfma_f32_16x16x32_bf16 v[192:195], v[72:75], v[56:59], v[192:195]
    v_mfma_f32_16x16x32_bf16 v[196:199], v[76:79], v[56:59], v[196:199]
    v_mfma_f32_16x16x32_bf16 v[184:187], v[64:67], v[60:63], v[184:187]
    v_mfma_f32_16x16x32_bf16 v[188:191], v[68:71], v[60:63], v[188:191]
    v_mfma_f32_16x16x32_bf16 v[200:203], v[72:75], v[60:63], v[200:203]
    v_mfma_f32_16x16x32_bf16 v[204:207], v[76:79], v[60:63], v[204:207]
    s_waitcnt lgkmcnt(0)
    s_barrier
    v_mfma_f32_16x16x32_bf16 v[144:147], v[96:99], v[80:83], v[144:147]
    ds_read_b128 v[16:19], v5 offset:0
    v_mfma_f32_16x16x32_bf16 v[148:151], v[100:103], v[80:83], v[148:151]
    ds_read_b128 v[32:35], v6 offset:0
    v_mfma_f32_16x16x32_bf16 v[160:163], v[104:107], v[80:83], v[160:163]
    ds_read_b128 v[20:23], v5 offset:256
    v_mfma_f32_16x16x32_bf16 v[164:167], v[108:111], v[80:83], v[164:167]
    ds_read_b128 v[36:39], v6 offset:256
    v_mfma_f32_16x16x32_bf16 v[152:155], v[96:99], v[84:87], v[152:155]
    ds_read_b128 v[24:27], v5 offset:4096
    v_mfma_f32_16x16x32_bf16 v[156:159], v[100:103], v[84:87], v[156:159]
    ds_read_b128 v[40:43], v6 offset:4096
    v_mfma_f32_16x16x32_bf16 v[168:171], v[104:107], v[84:87], v[168:171]
    ds_read_b128 v[28:31], v5 offset:4352
    v_mfma_f32_16x16x32_bf16 v[172:175], v[108:111], v[84:87], v[172:175]
    ds_read_b128 v[44:47], v6 offset:4352
    v_mfma_f32_16x16x32_bf16 v[176:179], v[96:99], v[88:91], v[176:179]
    ds_read_b128 v[48:51], v5 offset:2048
    v_mfma_f32_16x16x32_bf16 v[180:183], v[100:103], v[88:91], v[180:183]
    ds_read_b128 v[64:67], v6 offset:2048
    v_mfma_f32_16x16x32_bf16 v[192:195], v[104:107], v[88:91], v[192:195]
    ds_read_b128 v[52:55], v5 offset:2304
    v_mfma_f32_16x16x32_bf16 v[196:199], v[108:111], v[88:91], v[196:199]
    ds_read_b128 v[68:71], v6 offset:2304
    v_mfma_f32_16x16x32_bf16 v[184:187], v[96:99], v[92:95], v[184:187]
    ds_read_b128 v[56:59], v5 offset:6144
    v_mfma_f32_16x16x32_bf16 v[188:191], v[100:103], v[92:95], v[188:191]
    ds_read_b128 v[72:75], v6 offset:6144
    v_mfma_f32_16x16x32_bf16 v[200:203], v[104:107], v[92:95], v[200:203]
    ds_read_b128 v[60:63], v5 offset:6400
    v_mfma_f32_16x16x32_bf16 v[204:207], v[108:111], v[92:95], v[204:207]
    ds_read_b128 v[76:79], v6 offset:6400
    v_mfma_f32_16x16x32_bf16 v[144:147], v[128:131], v[112:115], v[144:147]
    v_mfma_f32_16x16x32_bf16 v[148:151], v[132:135], v[112:115], v[148:151]
    v_mfma_f32_16x16x32_bf16 v[160:163], v[136:139], v[112:115], v[160:163]
    v_mfma_f32_16x16x32_bf16 v[164:167], v[140:143], v[112:115], v[164:167]
    v_mfma_f32_16x16x32_bf16 v[152:155], v[128:131], v[116:119], v[152:155]
    s_add_u32 s25, s25, 32768
    s_cmp_eq_u32 s25, 131072
    s_cselect_b32 s25, 0, s25
    v_add_u32 v5, s25, v7
    v_add_u32 v6, s25, v8
    s_add_u32 s24, s24, 1
    v_mfma_f32_16x16x32_bf16 v[156:159], v[132:135], v[116:119], v[156:159]
    v_mfma_f32_16x16x32_bf16 v[168:171], v[136:139], v[116:119], v[168:171]
    v_mfma_f32_16x16x32_bf16 v[172:175], v[140:143], v[116:119], v[172:175]
    v_mfma_f32_16x16x32_bf16 v[176:179], v[128:131], v[120:123], v[176:179]
    v_mfma_f32_16x16x32_bf16 v[180:183], v[132:135], v[120:123], v[180:183]
    v_mfma_f32_16x16x32_bf16 v[192:195], v[136:139], v[120:123], v[192:195]
    v_mfma_f32_16x16x32_bf16 v[196:199], v[140:143], v[120:123], v[196:199]
    v_mfma_f32_16x16x32_bf16 v[184:187], v[128:131], v[124:127], v[184:187]
    v_mfma_f32_16x16x32_bf16 v[188:191], v[132:135], v[124:127], v[188:191]
    v_mfma_f32_16x16x32_bf16 v[200:203], v[136:139], v[124:127], v[200:203]
    v_mfma_f32_16x16x32_bf16 v[204:207], v[140:143], v[124:127], v[204:207]
    s_cmp_lt_u32 s24, 14
    s_cbranch_scc1 k3_loop
    s_waitcnt lgkmcnt(0)
    s_barrier
    v_mfma_f32_16x16x32_bf16 v[144:147], v[32:35], v[16:19], v[144:147]
    ds_read_b128 v[80:83], v5 offset:0
    v_mfma_f32_16x16x32_bf16 v[148:151], v[36:39], v[16:19], v[148:151]
    ds_read_b128 v[96:99], v6 offset:0
    v_mfma_f32_16x16x32_bf16 v[160:163], v[40:43], v[16:19], v[160:163]
    ds_read_b128 v[84:87], v5 offset:256
    v_mfma_f32_16x16x32_bf16 v[164:167], v[44:47], v[16:19], v[164:167]
    ds_read_b128 v[100:103], v6 offset:256
    v_mfma_f32_16x16x32_bf16 v[152:155], v[32:35], v[20:23], v[152:155]
    ds_read_b128 v[88:91], v5 offset:4096
    v_mfma_f32_16x16x32_bf16 v[156:159], v[36:39], v[20:23], v[156:159]
    ds_read_b128 v[104:107], v6 offset:4096
    v_mfma_f32_16x16x32_bf16 v[168:171], v[40:43], v[20:23], v[168:171]
    ds_read_b128 v[92:95], v5 offset:4352
    v_mfma_f32_16x16x32_bf16 v[172:175], v[44:47], v[20:23], v[172:175]
    ds_read_b128 v[108:111], v6 offset:4352
    v_mfma_f32_16x16x32_bf16 v[176:179], v[32:35], v[24:27], v[176:179]
    ds_read_b128 v[112:115], v5 offset:2048
    v_mfma_f32_16x16x32_bf16 v[180:183], v[36:39], v[24:27], v[180:183]
    ds_read_b128 v[128:131], v6 offset:2048
    v_mfma_f32_16x16x32_bf16 v[192:195], v[40:43], v[24:27], v[192:195]
    ds_read_b128 v[116:119], v5 offset:2304
    v_mfma_f32_16x16x32_bf16 v[196:199], v[44:47], v[24:27], v[196:199]
    ds_read_b128 v[132:135], v6 offset:2304
    v_mfma_f32_16x16x32_bf16 v[184:187], v[32:35], v[28:31], v[184:187]
    ds_read_b128 v[120:123], v5 offset:6144
    v_mfma_f32_16x16x32_bf16 v[188:191], v[36:39], v[28:31], v[188:191]
    ds_read_b128 v[136:139], v6 offset:6144
    v_mfma_f32_16x16x32_bf16 v[200:203], v[40:43], v[28:31], v[200:203]
    ds_read_b128 v[124:127], v5 offset:6400
    v_mfma_f32_16x16x32_bf16 v[204:207], v[44:47], v[28:31], v[204:207]
    ds_read_b128 v[140:143], v6 offset:6400
    v_mfma_f32_16x16x32_bf16 v[144:147], v[64:67], v[48:51], v[144:147]
    v_mfma_f32_16x16x32_bf16 v[148:151], v[68:71], v[48:51], v[148:151]
    v_mfma_f32_16x16x32_bf16 v[160:163], v[72:75], v[48:51], v[160:163]
    v_mfma_f32_16x16x32_bf16 v[164:167], v[76:79], v[48:51], v[164:167]
    v_mfma_f32_16x16x32_bf16 v[152:155], v[64:67], v[52:55], v[152:155]
    ds_read_b32 v4, v10
    v_mfma_f32_16x16x32_bf16 v[156:159], v[68:71], v[52:55], v[156:159]
    v_mfma_f32_16x16x32_bf16 v[168:171], v[72:75], v[52:55], v[168:171]
    v_mfma_f32_16x16x32_bf16 v[172:175], v[76:79], v[52:55], v[172:175]
    v_mfma_f32_16x16x32_bf16 v[176:179], v[64:67], v[56:59], v[176:179]
    v_mfma_f32_16x16x32_bf16 v[180:183], v[68:71], v[56:59], v[180:183]
    v_mfma_f32_16x16x32_bf16 v[192:195], v[72:75], v[56:59], v[192:195]
    v_mfma_f32_16x16x32_bf16 v[196:199], v[76:79], v[56:59], v[196:199]
    v_mfma_f32_16x16x32_bf16 v[184:187], v[64:67], v[60:63], v[184:187]
    v_mfma_f32_16x16x32_bf16 v[188:191], v[68:71], v[60:63], v[188:191]
    v_mfma_f32_16x16x32_bf16 v[200:203], v[72:75], v[60:63], v[200:203]
    v_mfma_f32_16x16x32_bf16 v[204:207], v[76:79], v[60:63], v[204:207]
    s_waitcnt lgkmcnt(0)
    v_mfma_f32_16x16x32_bf16 v[144:147], v[96:99], v[80:83], v[144:147]
    v_mfma_f32_16x16x32_bf16 v[148:151], v[100:103], v[80:83], v[148:151]
    v_mfma_f32_16x16x32_bf16 v[160:163], v[104:107], v[80:83], v[160:163]
    v_mfma_f32_16x16x32_bf16 v[164:167], v[108:111], v[80:83], v[164:167]
    v_mfma_f32_16x16x32_bf16 v[144:147], v[128:131], v[112:115], v[144:147]
    v_mfma_f32_16x16x32_bf16 v[148:151], v[132:135], v[112:115], v[148:151]
    v_mfma_f32_16x16x32_bf16 v[160:163], v[136:139], v[112:115], v[160:163]
    v_mfma_f32_16x16x32_bf16 v[164:167], v[140:143], v[112:115], v[164:167]
    v_mfma_f32_16x16x32_bf16 v[152:155], v[96:99], v[84:87], v[152:155]
    v_mfma_f32_16x16x32_bf16 v[156:159], v[100:103], v[84:87], v[156:159]
    v_cvt_pk_bf16_f32 v16, v144, v145
    v_cvt_pk_bf16_f32 v17, v146, v147
    v_cvt_pk_bf16_f32 v18, v148, v149
    v_mfma_f32_16x16x32_bf16 v[168:171], v[104:107], v[84:87], v[168:171]
    v_cvt_pk_bf16_f32 v19, v150, v151
    v_cvt_pk_bf16_f32 v24, v160, v161
    v_cvt_pk_bf16_f32 v25, v162, v163
    v_mfma_f32_16x16x32_bf16 v[172:175], v[108:111], v[84:87], v[172:175]
    v_cvt_pk_bf16_f32 v26, v164, v165
    v_cvt_pk_bf16_f32 v27, v166, v167
    v_mov_b32 v48, v16
    v_mfma_f32_16x16x32_bf16 v[152:155], v[128:131], v[116:119], v[152:155]
    v_mov_b32 v49, v17
    v_mov_b32 v50, v18
    v_mov_b32 v51, v19
    v_mfma_f32_16x16x32_bf16 v[156:159], v[132:135], v[116:119], v[156:159]
    v_mov_b32_dpp v16, v24 row_ror:8 row_mask:0xf bank_mask:0xc
    v_mov_b32_dpp v17, v25 row_ror:8 row_mask:0xf bank_mask:0xc
    v_mov_b32_dpp v18, v26 row_ror:8 row_mask:0xf bank_mask:0xc
    v_mfma_f32_16x16x32_bf16 v[168:171], v[136:139], v[116:119], v[168:171]
    v_mov_b32_dpp v19, v27 row_ror:8 row_mask:0xf bank_mask:0xc
    buffer_store_dwordx4 v[16:19], v11, s[88:91], s29 offen sc1 nt
    v_mov_b32_dpp v24, v48 row_ror:8 row_mask:0xf bank_mask:0x3
    v_mfma_f32_16x16x32_bf16 v[172:175], v[140:143], v[116:119], v[172:175]
    v_mov_b32_dpp v25, v49 row_ror:8 row_mask:0xf bank_mask:0x3
    v_mov_b32_dpp v26, v50 row_ror:8 row_mask:0xf bank_mask:0x3
    v_mov_b32_dpp v27, v51 row_ror:8 row_mask:0xf bank_mask:0x3
    buffer_store_dwordx4 v[24:27], v12, s[88:91], s29 offen sc1 nt
    v_mfma_f32_16x16x32_bf16 v[176:179], v[96:99], v[88:91], v[176:179]
    v_mfma_f32_16x16x32_bf16 v[180:183], v[100:103], v[88:91], v[180:183]
    v_cvt_pk_bf16_f32 v20, v152, v153
    v_cvt_pk_bf16_f32 v21, v154, v155
    v_cvt_pk_bf16_f32 v22, v156, v157
    v_mfma_f32_16x16x32_bf16 v[192:195], v[104:107], v[88:91], v[192:195]
    v_cvt_pk_bf16_f32 v23, v158, v159
    v_cvt_pk_bf16_f32 v28, v168, v169
    v_cvt_pk_bf16_f32 v29, v170, v171
    v_mfma_f32_16x16x32_bf16 v[196:199], v[108:111], v[88:91], v[196:199]
    v_cvt_pk_bf16_f32 v30, v172, v173
    v_cvt_pk_bf16_f32 v31, v174, v175
    v_mov_b32 v52, v20
    v_mfma_f32_16x16x32_bf16 v[176:179], v[128:131], v[120:123], v[176:179]
    v_mov_b32 v53, v21
    v_mov_b32 v54, v22
    v_mov_b32 v55, v23
    v_mfma_f32_16x16x32_bf16 v[180:183], v[132:135], v[120:123], v[180:183]
    v_mov_b32_dpp v20, v28 row_ror:8 row_mask:0xf bank_mask:0xc
    v_mov_b32_dpp v21, v29 row_ror:8 row_mask:0xf bank_mask:0xc
    v_mov_b32_dpp v22, v30 row_ror:8 row_mask:0xf bank_mask:0xc
    v_mfma_f32_16x16x32_bf16 v[192:195], v[136:139], v[120:123], v[192:195]
    v_mov_b32_dpp v23, v31 row_ror:8 row_mask:0xf bank_mask:0xc
    buffer_store_dwordx4 v[20:23], v11, s[88:91], s30 offen sc1 nt
    v_mov_b32_dpp v28, v52 row_ror:8 row_mask:0xf bank_mask:0x3
    v_mfma_f32_16x16x32_bf16 v[196:199], v[140:143], v[120:123], v[196:199]
    v_mov_b32_dpp v29, v53 row_ror:8 row_mask:0xf bank_mask:0x3
    v_mov_b32_dpp v30, v54 row_ror:8 row_mask:0xf bank_mask:0x3
    v_mov_b32_dpp v31, v55 row_ror:8 row_mask:0xf bank_mask:0x3
    buffer_store_dwordx4 v[28:31], v12, s[88:91], s30 offen sc1 nt
    v_mfma_f32_16x16x32_bf16 v[184:187], v[96:99], v[92:95], v[184:187]
    v_mfma_f32_16x16x32_bf16 v[188:191], v[100:103], v[92:95], v[188:191]
    v_cvt_pk_bf16_f32 v32, v176, v177
    v_cvt_pk_bf16_f32 v33, v178, v179
    v_cvt_pk_bf16_f32 v34, v180, v181
    v_mfma_f32_16x16x32_bf16 v[200:203], v[104:107], v[92:95], v[200:203]
    v_cvt_pk_bf16_f32 v35, v182, v183
    v_cvt_pk_bf16_f32 v40, v192, v193
    v_cvt_pk_bf16_f32 v41, v194, v195
    v_mfma_f32_16x16x32_bf16 v[204:207], v[108:111], v[92:95], v[204:207]
    v_cvt_pk_bf16_f32 v42, v196, v197
    v_cvt_pk_bf16_f32 v43, v198, v199
    v_mov_b32 v56, v32
    v_mfma_f32_16x16x32_bf16 v[184:187], v[128:131], v[124:127], v[184:187]
    v_mov_b32 v57, v33
    v_mov_b32 v58, v34
    v_mov_b32 v59, v35
    v_mfma_f32_16x16x32_bf16 v[188:191], v[132:135], v[124:127], v[188:191]
    v_mov_b32_dpp v32, v40 row_ror:8 row_mask:0xf bank_mask:0xc
    v_mov_b32_dpp v33, v41 row_ror:8 row_mask:0xf bank_mask:0xc
    v_mov_b32_dpp v34, v42 row_ror:8 row_mask:0xf bank_mask:0xc
    v_mfma_f32_16x16x32_bf16 v[200:203], v[136:139], v[124:127], v[200:203]
    v_mov_b32_dpp v35, v43 row_ror:8 row_mask:0xf bank_mask:0xc
    buffer_store_dwordx4 v[32:35], v11, s[88:91], s31 offen sc1 nt
    v_mov_b32_dpp v40, v56 row_ror:8 row_mask:0xf bank_mask:0x3
    v_mfma_f32_16x16x32_bf16 v[204:207], v[140:143], v[124:127], v[204:207]
    v_mov_b32_dpp v41, v57 row_ror:8 row_mask:0xf bank_mask:0x3
    v_mov_b32_dpp v42, v58 row_ror:8 row_mask:0xf bank_mask:0x3
    v_mov_b32_dpp v43, v59 row_ror:8 row_mask:0xf bank_mask:0x3
    buffer_store_dwordx4 v[40:43], v12, s[88:91], s31 offen sc1 nt
    s_nop 4
    v_cvt_pk_bf16_f32 v36, v184, v185
    v_cvt_pk_bf16_f32 v37, v186, v187
    v_cvt_pk_bf16_f32 v38, v188, v189
    v_cvt_pk_bf16_f32 v39, v190, v191
    v_cvt_pk_bf16_f32 v44, v200, v201
    v_cvt_pk_bf16_f32 v45, v202, v203
    v_cvt_pk_bf16_f32 v46, v204, v205
    v_cvt_pk_bf16_f32 v47, v206, v207
    v_mov_b32 v60, v36
    v_mov_b32 v61, v37
    v_mov_b32 v62, v38
    v_mov_b32 v63, v39
    v_mov_b32_dpp v36, v44 row_ror:8 row_mask:0xf bank_mask:0xc
    v_mov_b32_dpp v37, v45 row_ror:8 row_mask:0xf bank_mask:0xc
    v_mov_b32_dpp v38, v46 row_ror:8 row_mask:0xf bank_mask:0xc
    v_mov_b32_dpp v39, v47 row_ror:8 row_mask:0xf bank_mask:0xc
    buffer_store_dwordx4 v[36:39], v11, s[88:91], s32 offen sc1 nt
    v_mov_b32_dpp v44, v60 row_ror:8 row_mask:0xf bank_mask:0x3
    v_mov_b32_dpp v45, v61 row_ror:8 row_mask:0xf bank_mask:0x3
    v_mov_b32_dpp v46, v62 row_ror:8 row_mask:0xf bank_mask:0x3
    v_mov_b32_dpp v47, v63 row_ror:8 row_mask:0xf bank_mask:0x3
    buffer_store_dwordx4 v[44:47], v12, s[88:91], s32 offen sc1 nt
    s_cmp_ge_i32 s94, 0
    s_cbranch_scc1 k3_next
    v_mov_b32 v208, v4

k3_chk:
    s_waitcnt lgkmcnt(0)
    v_cmp_ne_u32 vcc, 0, v208
    s_cbranch_vccz k2_end
    s_mov_b32 s94, 0
    s_mov_b32 s97, 1

k3_next:
    s_cmp_ge_u32 s94, 256
    s_cbranch_scc1 k2_end
    s_lshr_b32 s29, s94, 2
    s_and_b32 s30, s94, 3
    s_lshl_b32 s30, s30, 3
    s_nop 3
    v_readlane_b32 s31, v208, s29
    s_mov_b32 s93, s94
    s_add_u32 s94, s94, 1
    s_nop 3
    s_lshr_b32 s31, s31, s30
    s_and_b32 s31, s31, 0xff
    s_cbranch_scc0 k3_next
    s_branch k3_tile

k3_skip:
    s_cmp_ge_i32 s94, 0
    s_cbranch_scc1 k3_next
    v_add_u32 v4, 131328, v211
    ds_read_b32 v208, v4
    s_branch k3_chk

k2_end:
    s_endpgm
k2_side_4:
    s_cmp_lt_u32 s21, 6
    s_cbranch_scc1 k2_side_4a
    s_waitcnt vmcnt(0)
    s_branch k2_back_4
k2_side_4a:
    s_mov_b32 m0, s38
    s_nop 0
    buffer_load_dwordx4 v7, s[8:11], s32 offen lds
    buffer_load_dwordx4 v7, s[8:11], s33 offen offset:1024 lds
    buffer_load_dwordx4 v[136:139], v208, s[12:15], s39 offen
    s_add_u32 s39, s39, 16384
    buffer_load_dwordx4 v[140:143], v208, s[12:15], s39 offen
    s_add_u32 s39, s39, 16384
    s_branch k2_back_4
k2_side_7:
    s_cmp_lt_u32 s21, 6
    s_cbranch_scc1 k2_side_7a
    s_cmp_lg_u32 s18, 4
    s_cbranch_scc1 k2_back_7
    v_mov_b32 v3, 0
    v_mov_b32 v4, 1
    s_add_u32 s27, s95, 32768
    s_mov_b64 exec, 1
    buffer_store_dword v4, v3, s[12:15], s27 offen sc1
    buffer_store_dword v4, v3, s[12:15], s99 offen sc1
    s_mov_b64 exec, -1

    s_branch k2_back_7
k2_side_7a:
    s_mov_b32 s76, 6
    buffer_load_dwordx4 v[144:147], v208, s[12:15], s39 offen
    s_add_u32 s39, s39, 16384
    buffer_load_dwordx4 v[148:151], v208, s[12:15], s39 offen
    s_add_u32 s39, s39, 16384
    buffer_load_dwordx4 v[168:171], v2, s[12:15], s40 offen offset:0
    buffer_load_dwordx4 v[172:175], v2, s[12:15], s40 offen offset:1024
    s_cmp_lg_u32 s18, 0
    s_cbranch_scc1 k2_back_7
    buffer_load_dwordx4 v[152:155], v209, s[12:15], s45 offen
    s_branch k2_back_7
k2_side_0:
    s_waitcnt vmcnt(5)
    v_add_f32 v136, v136, v140
    v_add_f32 v137, v137, v141
    v_add_f32 v138, v138, v142
    v_add_f32 v139, v139, v143
    v_add_f32 v144, v144, v148
    v_add_f32 v145, v145, v149
    v_add_f32 v146, v146, v150
    v_add_f32 v147, v147, v151
    v_add_f32 v136, v136, v144
    v_add_f32 v137, v137, v145
    v_add_f32 v138, v138, v146
    v_add_f32 v139, v139, v147
    ds_read_b64_tr_b16 v[192:193], v200 offset:0
    ds_read_b64_tr_b16 v[194:195], v200 offset:1024
    v_permlane32_swap_b32 v136, v138
    v_permlane32_swap_b32 v137, v139
    ds_read_b64_tr_b16 v[196:197], v200 offset:64
    ds_read_b64_tr_b16 v[198:199], v200 offset:1088
    v_add_f32 v136, v136, v138
    v_add_f32 v137, v137, v139
    s_cmp_lg_u32 s18, 0
    v_cvt_pk_bf16_f32 v140, v136, v137
    ds_write_b32 v201, v140
    s_cbranch_scc1 k2_back_0
    v_add_f32_dpp v152, v152, v152 quad_perm:[1,0,3,2] row_mask:0xf bank_mask:0xf
    v_add_f32_dpp v153, v153, v153 quad_perm:[1,0,3,2] row_mask:0xf bank_mask:0xf
    v_add_f32_dpp v154, v154, v154 quad_perm:[1,0,3,2] row_mask:0xf bank_mask:0xf
    v_add_f32_dpp v155, v155, v155 quad_perm:[1,0,3,2] row_mask:0xf bank_mask:0xf
    v_add_f32_dpp v152, v152, v152 quad_perm:[2,3,0,1] row_mask:0xf bank_mask:0xf
    v_add_f32_dpp v153, v153, v153 quad_perm:[2,3,0,1] row_mask:0xf bank_mask:0xf
    v_add_f32_dpp v154, v154, v154 quad_perm:[2,3,0,1] row_mask:0xf bank_mask:0xf
    v_add_f32_dpp v155, v155, v155 quad_perm:[2,3,0,1] row_mask:0xf bank_mask:0xf
    v_add_f32_dpp v152, v152, v152 row_half_mirror row_mask:0xf bank_mask:0xf
    v_add_f32_dpp v153, v153, v153 row_half_mirror row_mask:0xf bank_mask:0xf
    v_add_f32_dpp v154, v154, v154 row_half_mirror row_mask:0xf bank_mask:0xf
    v_add_f32_dpp v155, v155, v155 row_half_mirror row_mask:0xf bank_mask:0xf
    v_cvt_pk_bf16_f32 v156, v152, v153
    v_cvt_pk_bf16_f32 v157, v154, v155
    ds_write_b64 v210, v[156:157]
    s_branch k2_back_0
k2_side_6:
    ds_read_b128 v[176:179], v202 offset:0
    ds_read_b128 v[180:183], v202 offset:1024
    ds_read_b128 v[184:187], v211 offset:0
    ds_read_b128 v[188:191], v211 offset:32
    buffer_store_dwordx4 v[192:195], v207, s[12:15], s34 offen sc1
    buffer_store_dwordx4 v[196:199], v207, s[12:15], s35 offen sc1
    s_branch k2_back_6
k2_side_1:
    v_mfma_f32_32x32x16_bf16 v[136:151], v[176:179], v[168:171], 0
    v_mfma_f32_32x32x16_bf16 v[152:167], v[184:187], v[168:171], 0
    v_mfma_f32_32x32x16_bf16 v[136:151], v[180:183], v[172:175], v[136:151]
    v_mfma_f32_32x32x16_bf16 v[152:167], v[188:191], v[172:175], v[152:167]
    s_branch k2_back_1
k2_side_3:
    v_add_f32 v203, s43, v152
    v_rcp_f32 v203, v203
    s_nop 0
    v_mul_f32 v136, v136, v203
    v_mul_f32 v137, v137, v203
    v_mul_f32 v138, v138, v203
    v_mul_f32 v139, v139, v203
    v_mul_f32 v140, v140, v203
    v_mul_f32 v141, v141, v203
    v_mul_f32 v142, v142, v203
    v_mul_f32 v143, v143, v203
    v_mul_f32 v144, v144, v203
    v_mul_f32 v145, v145, v203
    v_mul_f32 v146, v146, v203
    v_mul_f32 v147, v147, v203
    v_mul_f32 v148, v148, v203
    v_mul_f32 v149, v149, v203
    v_mul_f32 v150, v150, v203
    v_mul_f32 v151, v151, v203
    v_cvt_pk_bf16_f32 v168, v136, v137
    v_cvt_pk_bf16_f32 v169, v138, v139
    v_cvt_pk_bf16_f32 v170, v140, v141
    v_cvt_pk_bf16_f32 v171, v142, v143
    v_cvt_pk_bf16_f32 v172, v144, v145
    v_cvt_pk_bf16_f32 v173, v146, v147
    v_cvt_pk_bf16_f32 v174, v148, v149
    v_cvt_pk_bf16_f32 v175, v150, v151
    buffer_store_dwordx4 v[168:171], v2, s[12:15], s41 offen offset:0 sc1
    buffer_store_dwordx4 v[172:175], v2, s[12:15], s41 offen offset:1024 sc1
    s_branch k2_back_3
k2_fallback:
    s_waitcnt vmcnt(0) lgkmcnt(0)
    s_lshl_b32 s20, s16, 18
    s_add_u32 s20, s20, 4194304
    s_mov_b32 s28, s20
    s_mov_b32 s21, 0
    v_mov_b32 v3, 0xff800000

k2_fb1:
    buffer_load_dwordx4 v[16:19], v214, s[12:15], s28 offen offset:0
    buffer_load_dwordx4 v[20:23], v214, s[12:15], s28 offen offset:1024
    s_waitcnt vmcnt(0)
    v_mfma_f32_32x32x16_bf16 v[48:63], v[16:19], v[8:11], 0
    v_mfma_f32_32x32x16_bf16 v[48:63], v[20:23], v[12:15], v[48:63]
    s_nop 15

    v_max3_f32 v3, v3, v48, v49
    v_max3_f32 v3, v3, v50, v51
    v_max3_f32 v3, v3, v52, v53
    v_max3_f32 v3, v3, v54, v55
    v_max3_f32 v3, v3, v56, v57
    v_max3_f32 v3, v3, v58, v59
    v_max3_f32 v3, v3, v60, v61
    v_max3_f32 v3, v3, v62, v63
    s_add_u32 s28, s28, 4096
    s_add_u32 s21, s21, 1
    s_cmp_lt_u32 s21, 64
    s_cbranch_scc1 k2_fb1
    v_mov_b32 v4, v3
    s_nop 1
    v_permlane32_swap_b32 v3, v4
    s_nop 1
    v_max_f32 v3, v3, v4

    v_sub_f32 v80, 0, v3
    v_sub_f32 v81, 0, v3
    v_sub_f32 v82, 0, v3
    v_sub_f32 v83, 0, v3
    v_sub_f32 v84, 0, v3
    v_sub_f32 v85, 0, v3
    v_sub_f32 v86, 0, v3
    v_sub_f32 v87, 0, v3
    v_sub_f32 v88, 0, v3
    v_sub_f32 v89, 0, v3
    v_sub_f32 v90, 0, v3
    v_sub_f32 v91, 0, v3
    v_sub_f32 v92, 0, v3
    v_sub_f32 v93, 0, v3
    v_sub_f32 v94, 0, v3
    v_sub_f32 v95, 0, v3
    v_mov_b32 v96, 0
    v_mov_b32 v97, 0
    v_mov_b32 v98, 0
    v_mov_b32 v99, 0
    v_mov_b32 v100, 0
    v_mov_b32 v101, 0
    v_mov_b32 v102, 0
    v_mov_b32 v103, 0
    v_mov_b32 v104, 0
    v_mov_b32 v105, 0
    v_mov_b32 v106, 0
    v_mov_b32 v107, 0
    v_mov_b32 v108, 0
    v_mov_b32 v109, 0
    v_mov_b32 v110, 0
    v_mov_b32 v111, 0
    v_mov_b32 v128, 0
    v_mov_b32 v129, 0
    v_mov_b32 v130, 0
    v_mov_b32 v131, 0
    s_mov_b32 s28, s20
    s_mov_b32 s21, 0

k2_fb2:
    buffer_load_dwordx4 v[16:19], v214, s[12:15], s28 offen offset:0
    buffer_load_dwordx4 v[20:23], v214, s[12:15], s28 offen offset:1024
    buffer_load_dwordx4 v[32:35], v2, s[12:15], s28 offen offset:2048
    buffer_load_dwordx4 v[36:39], v2, s[12:15], s28 offen offset:3072
    s_waitcnt vmcnt(0)
    v_mfma_f32_32x32x16_bf16 v[48:63], v[16:19], v[8:11], v[80:95]
    v_mfma_f32_32x32x16_bf16 v[48:63], v[20:23], v[12:15], v[48:63]
    s_nop 15

    v_exp_f32 v48, v48
    v_exp_f32 v49, v49
    v_exp_f32 v50, v50
    v_exp_f32 v51, v51
    v_exp_f32 v52, v52
    v_exp_f32 v53, v53
    v_exp_f32 v54, v54
    v_exp_f32 v55, v55
    v_exp_f32 v56, v56
    v_exp_f32 v57, v57
    v_exp_f32 v58, v58
    v_exp_f32 v59, v59
    v_exp_f32 v60, v60
    v_exp_f32 v61, v61
    v_exp_f32 v62, v62
    v_exp_f32 v63, v63
    s_nop 2
    v_smfmac_f32_32x32x32_bf16 v[96:111], v[32:35], v[48:55], v206
    v_smfmac_f32_16x16x64_bf16 v[128:131], v[132:135], v[48:55], v206
    v_smfmac_f32_32x32x32_bf16 v[96:111], v[36:39], v[56:63], v206
    v_smfmac_f32_16x16x64_bf16 v[128:131], v[132:135], v[56:63], v206
    s_add_u32 s28, s28, 4096
    s_add_u32 s21, s21, 1
    s_cmp_lt_u32 s21, 64
    s_nop 7
    s_cbranch_scc1 k2_fb2
    s_nop 7
    s_branch k2_fin

text_end:
.section .rodata,"a"
.p2align 6
.amdhsa_kernel qkv_kernel
  .amdhsa_next_free_vgpr 192
  .amdhsa_next_free_sgpr 102
  .amdhsa_accum_offset 192
  .amdhsa_group_segment_fixed_size 0
  .amdhsa_kernarg_size 72
  .amdhsa_user_sgpr_count 2
  .amdhsa_user_sgpr_kernarg_segment_ptr 1
  .amdhsa_system_sgpr_workgroup_id_x 1
.end_amdhsa_kernel
.amdhsa_kernel attn_kernel
  .amdhsa_next_free_vgpr 216
  .amdhsa_next_free_sgpr 102
  .amdhsa_accum_offset 216
  .amdhsa_group_segment_fixed_size 0
  .amdhsa_kernarg_size 72
  .amdhsa_user_sgpr_count 2
  .amdhsa_user_sgpr_kernarg_segment_ptr 1
  .amdhsa_system_sgpr_workgroup_id_x 1
.end_amdhsa_kernel
```
